```python
import torch

def _softmax(x, axis=-1):
    return torch.softmax(x, dim=axis)
def _gelu(x):
    return torch.nn.functional.gelu(x, approximate="tanh")
def _silu(x):
    return torch.nn.functional.silu(x)
def _sigmoid(x):
    return torch.sigmoid(x)
def _layernorm(x, axis=-1, eps=1e-5):
    m = x.mean(dim=axis, keepdim=True)
    v = x.var(dim=axis, keepdim=True, unbiased=False)
    return (x - m) / torch.sqrt(v + eps)
def _scatter_add(tgt, idx, src, axis=0):
    return tgt.clone().index_add_(axis, idx, src)
def _segment_sum(src, seg, n):
    out = torch.zeros((n,) + src.shape[1:], dtype=src.dtype)
    return out.index_add_(0, seg, src)
def _pad(x, pw):
    flat = tuple(v for pair in reversed(pw) for v in pair)
    return torch.nn.functional.pad(x, flat)

kernel_name = 'gated_mix__ssm_conv_s5__dense_activation_squared_relu__prompt'

def setup_inputs():

    _w = (lambda a: (lambda t: t.to(torch.bfloat16) if t.is_floating_point() else t)(torch.as_tensor(a)))
    def _A_setup():
        B, S, D = 1, 2048, 512
        P = D
        Lambda_re = -0.5 * (lambda _x: torch.exp(torch.as_tensor(_x)))((lambda *s: torch.randn(*s, dtype=torch.bfloat16) * 0.4)(P))
        Lambda_im = (lambda *s: torch.randn(*s, dtype=torch.bfloat16) * 0.8)(P) * 1.0
        B_re = (lambda *s: torch.randn(*s, dtype=torch.bfloat16) * 0.8)(P, D) * (D ** -0.5)
        B_im = (lambda *s: torch.randn(*s, dtype=torch.bfloat16) * 0.8)(P, D) * (D ** -0.5)
        C_re = (lambda *s: torch.randn(*s, dtype=torch.bfloat16) * 0.8)(D, P) * (P ** -0.5)
        C_im = (lambda *s: torch.randn(*s, dtype=torch.bfloat16) * 0.8)(D, P) * (P ** -0.5)
        log_dt = (lambda *s: torch.randn(*s, dtype=torch.bfloat16) * 0.4)(P) * 0.3 - 2.0
        Dskip = (lambda *s: torch.randn(*s, dtype=torch.bfloat16) * 0.1)(D)
        return {
            "x": _w((lambda *s: torch.randn(*s, dtype=torch.bfloat16) * 0.05)(B, S, D)),
            "Lambda_re": _w(Lambda_re),
            "Lambda_im": _w(Lambda_im),
            "B_re": _w(B_re),
            "B_im": _w(B_im),
            "C_re": _w(C_re),
            "C_im": _w(C_im),
            "log_dt": _w(log_dt),
            "Dskip": _w(Dskip),
        }
    _A_in = _A_setup()

    def _B_setup():
        B, S, D, F = 1, 2048, 512, 1792
        return {
            "x": _w((lambda *s: torch.randn(*s, dtype=torch.bfloat16) * 0.05)(B, S, D)),
            "w1": _w((lambda *s: torch.randn(*s, dtype=torch.bfloat16) * 0.05)(D, F)),
            "b1": _w((lambda *s: torch.randn(*s, dtype=torch.bfloat16) * 0.05)(F)),
            "w2": _w((lambda *s: torch.randn(*s, dtype=torch.bfloat16) * 0.05)(F, D)),
            "b2": _w((lambda *s: torch.randn(*s, dtype=torch.bfloat16) * 0.05)(D)),
        }
    _B_in = _B_setup()

    return {
        "A_x": _A_in["x"],
        "A_Lambda_re": _A_in["Lambda_re"],
        "A_Lambda_im": _A_in["Lambda_im"],
        "A_B_re": _A_in["B_re"],
        "A_B_im": _A_in["B_im"],
        "A_C_re": _A_in["C_re"],
        "A_C_im": _A_in["C_im"],
        "A_log_dt": _A_in["log_dt"],
        "A_Dskip": _A_in["Dskip"],
        "B_x": _B_in["x"],
        "B_w1": _B_in["w1"],
        "B_b1": _B_in["b1"],
        "B_w2": _B_in["w2"],
        "B_b2": _B_in["b2"],
        "gate_w": _w((lambda *s: torch.randn(*s, dtype=torch.bfloat16) * 0.05)(512) * 16.0),
    }

def reference(A_x, A_Lambda_re, A_Lambda_im, A_B_re, A_B_im, A_C_re, A_C_im, A_log_dt, A_Dskip, B_x, B_w1, B_b1, B_w2, B_b2, gate_w):
    def _A_ref(x, Lambda_re, Lambda_im, B_re, B_im, C_re, C_im, log_dt, Dskip):
        Bsz, L, H = x.shape
        Lam = Lambda_re + 1j * Lambda_im
        Bmat = B_re + 1j * B_im
        Cmat = C_re + 1j * C_im
        dt = torch.exp(log_dt)
        Lam_bar = torch.exp(dt * Lam)
        B_bar = ((Lam_bar - 1.0) / Lam)[:, None] * Bmat
        Bu = torch.einsum("bld,pd->blp", x + 0j, B_bar)
        h = torch.zeros_like(Bu[:, 0, :])
        hs = []
        for t in range(L):
            h = Lam_bar[None, :] * h + Bu[:, t, :]
            hs.append(h)
        hseq = torch.stack(hs, 1)
        y = 2.0 * torch.einsum("blp,dp->bld", hseq, Cmat).real + x * Dskip[None, None, :]
        return y

    def _B_ref(x, w1, b1, w2, b2):
        h = torch.einsum("bsd,df->bsf", x, w1) + b1
        zero = torch.zeros_like(h)
        r = torch.where(h > zero, h, zero)
        h = r * r
        out = torch.einsum("bsf,fd->bsd", h, w2) + b2
        return out

    x = A_x
    g = _sigmoid((x * gate_w).sum(-1, keepdims=True))
    a = _A_ref(x, A_Lambda_re, A_Lambda_im, A_B_re, A_B_im, A_C_re, A_C_im, A_log_dt, A_Dskip)
    b = _B_ref(x, B_w1, B_b1, B_w2, B_b2)
    return g * a + (1 - g) * b
```

```asm
; @launch grid=(256,1,1) block=(256,1,1) lds=163840
.amdgcn_target "amdgcn-amd-amdhsa--gfx950"
.text
.globl gated_mix__ssm_conv_s5__dense_activation_squared_relu__prompt_kernel
.p2align 8
.type gated_mix__ssm_conv_s5__dense_activation_squared_relu__prompt_kernel,@function
gated_mix__ssm_conv_s5__dense_activation_squared_relu__prompt_kernel:
    s_cmp_ge_u32 s2, 256
    s_cbranch_scc1 L_k1_end
    s_load_dwordx16 s[16:31], s[0:1], 0
    s_load_dwordx16 s[32:47], s[0:1], 64
    s_load_dwordx4 s[48:51], s[0:1], 128
    s_getpc_b64 s[60:61]
L_pc:
    s_and_b32 s61, s61, 0xffff
    s_mov_b32 s62, L_code_end-L_pc
    s_mov_b32 s63, 0x20000
    s_lshr_b32 s3, s2, 3
    s_lshl_b32 s3, s3, 10
    v_lshlrev_b32 v4, 2, v0
    v_add_u32 v4, s3, v4
    buffer_load_dword v252, v4, s[60:63], 0 offen
    v_and_b32 v1, 63, v0
    v_lshrrev_b32 v4, 6, v0
    v_and_b32 v2, 15, v1
    v_readfirstlane_b32 s6, v4
    v_lshrrev_b32 v3, 4, v1
    s_lshr_b32 s3, s2, 1
    s_and_b32 s3, s3, 3
    s_lshr_b32 s7, s2, 6
    s_lshl_b32 s7, s7, 2
    s_add_u32 s4, s3, s7
    s_lshr_b32 s5, s2, 3
    s_and_b32 s5, s5, 7
    s_and_b32 s7, s2, 1
    s_lshl_b32 s7, s7, 3
    s_add_u32 s5, s5, s7
    v_xor_b32 v4, v2, v3
    v_lshlrev_b32_e64 v4, 4, v4
    v_lshl_or_b32 v5, v3, 10, v4
    v_mov_b32 v96, v5
    v_add_u32 v97, 3072, v5
    v_xor_b32 v98, 64, v5
    v_add_u32 v98, 6144, v98
    v_xor_b32 v99, 64, v5
    v_add_u32 v99, 9216, v99
    s_lshl_b32 s64, s4, 7
    s_lshl_b32 s3, s6, 5
    s_add_u32 s64, s64, s3
    s_lshl_b32 s64, s64, 10
    s_lshl_b32 s67, s6, 13
    s_add_u32 s82, s4, s5
    s_add_u32 s3, s82, 0
    s_and_b32 s3, s3, 3
    s_lshl_b32 s7, s3, 8
    s_add_u32 s72, s64, s7
    s_waitcnt lgkmcnt(0)
    s_mov_b32 s8, s16
    s_and_b32 s9, s17, 0xffff
    s_mov_b32 s10, 0x200000
    s_mov_b32 s11, 0x20000
    s_add_u32 m0, s67, 65536
    s_mov_b32 s70, s72
    buffer_load_dwordx4 v96, s[8:11], s70 offen lds
    v_xor_b32 v100, 128, v5
    v_xor_b32 v101, 128, v5
    buffer_load_dwordx4 v97, s[8:11], s70 offen offset:1024 lds
    v_add_u32 v101, 3072, v101
    v_xor_b32 v102, 192, v5
    buffer_load_dwordx4 v98, s[8:11], s70 offen offset:2048 lds
    v_add_u32 v102, 6144, v102
    v_xor_b32 v103, 192, v5
    buffer_load_dwordx4 v99, s[8:11], s70 offen offset:3072 lds
    v_add_u32 v103, 9216, v103
    s_add_u32 m0, s67, 69632
    s_add_u32 s70, s72, 16384
    buffer_load_dwordx4 v100, s[8:11], s70 offen lds
    v_mov_b32_e64 v104, v5
    v_xor_b32_e64 v105, 64, v5
    v_add_u32 v105, 3072, v105
    buffer_load_dwordx4 v101, s[8:11], s70 offen offset:1024 lds
    v_xor_b32 v106, 128, v5
    v_add_u32 v106, 6144, v106
    v_xor_b32 v107, 192, v5
    buffer_load_dwordx4 v102, s[8:11], s70 offen offset:2048 lds
    v_add_u32 v107, 9216, v107
    s_lshl_b32 s65, s5, 5
    s_and_b32 s3, s6, 1
    s_lshl_b32 s3, s3, 4
    s_add_u32 s65, s65, s3
    s_lshl_b32 s65, s65, 10
    s_lshl_b32 s68, s6, 12
    s_cmp_lt_u32 s6, 2
    s_cselect_b32 s12, s22, s24
    s_cselect_b32 s13, s23, s25
    s_and_b32 s13, s13, 0xffff
    s_mov_b32 s14, 0x80000
    s_mov_b32 s15, 0x20000
    buffer_load_dwordx4 v103, s[8:11], s70 offen offset:3072 lds
    s_add_u32 s3, s82, 0
    s_and_b32 s3, s3, 3
    s_lshl_b32 s7, s3, 8
    s_add_u32 s34, s65, s7
    s_add_u32 m0, s68, 0
    s_mov_b32 s70, s34
    buffer_load_dwordx4 v104, s[12:15], s70 offen lds
    s_add_u32 s3, s82, 1
    s_and_b32 s3, s3, 3
    s_lshl_b32 s7, s3, 8
    s_add_u32 s73, s64, s7
    s_add_u32 s35, s65, s7
    s_mov_b32 s7, 11681792
    s_load_dword s97, s[50:51], s7
    s_lshl_b32 s3, s5, 5
    v_and_b32 v6, 31, v1
    v_add_u32_e64 v6, s3, v6
    v_lshlrev_b32_e64 v6, 1, v6
    buffer_load_dwordx4 v105, s[12:15], s70 offen offset:1024 lds
    global_load_ushort v208, v6, s[18:19]
    global_load_ushort v209, v6, s[20:21]
    global_load_ushort v210, v6, s[30:31]
    s_add_u32 s3, s82, 2
    s_and_b32 s3, s3, 3
    s_lshl_b32 s7, s3, 8
    s_add_u32 s74, s64, s7
    s_add_u32 s48, s65, s7
    buffer_load_dwordx4 v106, s[12:15], s70 offen offset:2048 lds
    s_add_u32 s3, s82, 3
    s_and_b32 s3, s3, 3
    s_lshl_b32 s7, s3, 8
    s_add_u32 s75, s64, s7
    s_add_u32 s49, s65, s7
    s_mul_i32 s66, s6, 114688
    s_mul_i32 s3, s5, 224
    s_add_u32 s66, s66, s3
    s_and_b32 s3, s5, 1
    s_lshl_b32 s3, s3, 5
    s_sub_u32 s66, s66, s3
    s_add_u32 s3, s82, 0
    s_and_b32 s3, s3, 3
    s_mul_i32 s7, s3, 458752
    s_add_u32 s85, s66, s7
    s_add_u32 s3, s82, 1
    s_and_b32 s3, s3, 3
    s_mul_i32 s7, s3, 458752
    s_add_u32 s86, s66, s7
    buffer_load_dwordx4 v107, s[12:15], s70 offen offset:3072 lds
    s_add_u32 s3, s82, 2
    s_and_b32 s3, s3, 3
    s_mul_i32 s7, s3, 458752
    s_add_u32 s87, s66, s7
    s_add_u32 s3, s82, 3
    s_and_b32 s3, s3, 3
    s_mul_i32 s7, s3, 458752
    s_add_u32 s88, s66, s7
    s_add_u32 m0, s67, 98304
    s_mov_b32 s70, s73
    buffer_load_dwordx4 v96, s[8:11], s70 offen lds
    v_xor_b32 v4, v2, v3
    v_lshrrev_b32 v5, 2, v2
    v_lshlrev_b32 v5, 3, v5
    v_and_b32 v6, 3, v2
    v_add_u32 v5, v5, v6
    v_lshlrev_b32 v5, 8, v5
    s_add_u32 s3, s67, 65536
    v_add_u32 v5, s3, v5
    v_lshlrev_b32 v6, 8, v2
    v_xor_b32 v7, 0, v4
    buffer_load_dwordx4 v97, s[8:11], s70 offen offset:1024 lds
    v_lshlrev_b32 v7, 4, v7
    v_add_u32 v108, v5, v7
    v_add_u32 v116, v6, v7
    v_add_u32 v112, 0x10000, v108
    v_xor_b32 v7, 4, v4
    v_lshlrev_b32 v7, 4, v7
    v_add_u32 v109, v5, v7
    v_add_u32 v117, v6, v7
    v_add_u32 v113, 0x10000, v109
    buffer_load_dwordx4 v98, s[8:11], s70 offen offset:2048 lds
    v_xor_b32 v7, 8, v4
    v_lshlrev_b32 v7, 4, v7
    v_add_u32 v110, v5, v7
    v_add_u32 v118, v6, v7
    v_add_u32 v114, 0x10000, v110
    v_xor_b32 v7, 12, v4
    v_lshlrev_b32_e64 v7, 4, v7
    v_add_u32_e64 v111, v5, v7
    v_add_u32_e64 v119, v6, v7
    buffer_load_dwordx4 v99, s[8:11], s70 offen offset:3072 lds
    v_add_u32 v115, 0x10000, v111
    s_mov_b32 s52, s36
    s_and_b32 s53, s37, 0xffff
    s_mov_b32 s54, 0x1c0000
    s_mov_b32 s55, 0x20000
    s_mov_b32 s56, s50
    s_and_b32 s57, s51, 0xffff
    s_mov_b32 s58, 0xb26100
    s_mov_b32 s59, 0x20000
    s_add_u32 m0, s67, 102400
    s_add_u32 s70, s73, 16384
    buffer_load_dwordx4 v100, s[8:11], s70 offen lds
    s_lshl_b32 s3, s5, 13
    s_add_u32 s3, s3, 11534336
    s_add_u32 s76, s50, s3
    s_addc_u32 s77, s51, 0
    s_and_b32 s77, s77, 0xffff
    s_mov_b32 s78, 8192
    s_mov_b32 s79, 0x20000
    s_mov_b32 s60, s38
    s_and_b32 s61, s39, 0xffff
    s_mov_b32 s62, 0xe00
    s_mov_b32 s63, 0x20000
    s_mov_b32 s80, 0x3fb8aa3b
    s_mov_b32 s81, 0x3e22f983
    buffer_load_dwordx4 v101, s[8:11], s70 offen offset:1024 lds
    v_mul_u32_u24 v4, 3584, v3
    v_and_b32 v5, 1, v1
    v_lshl_add_u32 v4, v5, 4, v4
    v_lshrrev_b32 v5, 1, v2
    v_xor_b32 v5, v5, v3
    v_xor_b32 v6, 4, v5
    v_lshl_add_u32 v5, v5, 5, v4
    v_lshl_add_u32 v6, v6, 5, v4
    v_mov_b32 v120, v5
    v_add_u32 v121, 27648, v6
    v_add_u32 v122, 55296, v5
    v_add_u32 v123, 82944, v6
    v_add_u32 v124, 14336, v5
    v_add_u32 v125, 41984, v6
    v_add_u32 v126, 69632, v5
    v_add_u32 v127, 97280, v6
    v_lshlrev_b32 v253, 2, v1
    v_lshrrev_b32 v4, 3, v1
    v_lshlrev_b32 v4, 10, v4
    v_and_b32 v5, 7, v1
    v_xor_b32 v5, v5, v3
    v_lshl_add_u32 v232, v5, 4, v4
    v_xor_b32 v5, 4, v5
    v_lshl_add_u32 v233, v5, 4, v4
    v_lshrrev_b32 v4, 3, v1
    v_lshlrev_b32 v4, 10, v4
    v_lshrrev_b32 v5, 1, v1
    v_xor_b32 v5, v5, v3
    v_and_b32 v5, 3, v5
    v_lshlrev_b32 v5, 1, v5
    v_and_b32 v6, 1, v1
    v_add_u32 v5, v5, v6
    v_lshl_add_u32 v231, v5, 4, v4
    v_lshrrev_b32 v5, 1, v2
    v_xor_b32 v5, v5, v3
    v_lshlrev_b32 v6, 7, v2
    v_add_u32 v6, s68, v6
    v_lshl_add_u32 v234, v5, 4, v6
    v_xor_b32 v5, 4, v5
    v_lshl_add_u32 v239, v5, 4, v6
    v_lshrrev_b32 v4, 2, v2
    v_lshl_add_u32 v4, v3, 2, v4
    v_lshlrev_b32 v4, 7, v4
    v_and_b32 v5, 3, v2
    v_lshl_add_u32 v4, v5, 3, v4
    v_add_u32 v4, s68, v4
    v_lshrrev_b32 v5, 3, v2
    v_lshl_add_u32 v5, v3, 1, v5
    v_xor_b32 v6, 0, v5
    v_and_b32 v6, 3, v6
    v_lshl_add_u32 v235, v6, 5, v4
    v_xor_b32 v6, 1, v5
    v_and_b32 v6, 3, v6
    v_lshl_add_u32 v236, v6, 5, v4
    v_xor_b32 v6, 2, v5
    v_and_b32 v6, 3, v6
    v_lshl_add_u32 v237, v6, 5, v4
    v_xor_b32 v6, 3, v5
    v_and_b32 v6, 3, v6
    v_lshl_add_u32 v238, v6, 5, v4
    v_lshrrev_b32 v4, 2, v2
    v_and_b32 v5, 1, v3
    v_lshl_add_u32 v5, v5, 2, v4
    v_lshl_add_u32 v4, v3, 2, v4
    v_lshlrev_b32 v4, 8, v4
    v_and_b32 v6, 3, v2
    v_lshl_add_u32 v4, v6, 3, v4
    v_add_u32 v4, 98304, v4
    s_bitcmp1_b32 s5, 0
    s_cselect_b32 s3, 2, 0
    v_xor_b32 v6, s3, v5
    v_lshl_add_u32 v240, v6, 5, v4
    s_bitcmp1_b32 s5, 0
    s_cselect_b32 s3, 3, 1
    v_xor_b32 v6, s3, v5
    v_lshl_add_u32 v241, v6, 5, v4
    s_bitcmp1_b32 s5, 0
    s_cselect_b32 s3, 4, 2
    v_xor_b32_e64 v6, s3, v5
    v_lshl_add_u32 v242, v6, 5, v4
    s_bitcmp1_b32 s5, 0
    s_cselect_b32 s3, 5, 3
    v_xor_b32 v6, s3, v5
    v_lshl_add_u32 v243, v6, 5, v4
    s_bitcmp1_b32 s5, 0
    s_cselect_b32 s3, 6, 4
    v_xor_b32 v6, s3, v5
    v_lshl_add_u32 v244, v6, 5, v4
    s_bitcmp1_b32 s5, 0
    s_cselect_b32 s3, 7, 5
    v_xor_b32_e64 v6, s3, v5
    v_lshl_add_u32 v245, v6, 5, v4
    s_bitcmp1_b32 s5, 0
    s_cselect_b32 s3, 1, 6
    v_xor_b32 v6, s3, v5
    v_lshl_add_u32 v250, v6, 5, v4
    s_mul_i32 s90, s6, 22
    s_and_b32 s3, s2, 1
    s_lshl_b32 s3, s3, 2
    s_lshr_b32 s7, s2, 4
    s_and_b32 s7, s7, 3
    s_add_u32 s89, s3, s7
    s_and_b32 s3, s2, 6
    s_lshr_b32 s7, s2, 3
    s_and_b32 s7, s7, 1
    s_add_u32 s3, s3, s7
    s_lshr_b32 s7, s2, 6
    s_lshl_b32 s7, s7, 3
    s_add_u32 s64, s3, s7
    s_lshl_b32 s7, s89, 16
    s_cmp_eq_u32 s6, 1
    s_cselect_b32 s3, 640, 0
    s_add_u32 s66, s3, s7
    s_cmp_eq_u32 s6, 1
    s_cselect_b32 s3, 768, 0
    s_add_u32 s69, s3, s7
    s_sub_u32 s3, s90, 32
    s_lshl_b32 s3, s3, 15
    s_lshl_b32 s7, s89, 7
    s_add_u32 s65, s3, s7
    s_sub_u32 s90, 32, s90
    s_and_b32 s27, s27, 0xffff
    s_and_b32 s29, s29, 0xffff
    s_and_b32 s41, s41, 0xffff
    s_waitcnt lgkmcnt(0)
    s_add_u32 s94, s97, 0x3c6ef372
    s_add_u32 s95, s97, 0x7f4a7c15
    s_add_u32 s97, s97, 0x9e3779b9
    s_waitcnt vmcnt(6)
    s_barrier
    ds_read_b128 a[0:3], v108 offset:0
    ds_read_b128 a[4:7], v108 offset:1024
    ds_read_b128 a[128:131], v116 offset:0
    ds_read_b128 a[132:135], v116 offset:4096
    ds_read_b128 a[136:139], v116 offset:8192
    ds_read_b128 a[140:143], v116 offset:12288
    s_waitcnt lgkmcnt(0)
    v_mfma_f32_16x16x32_bf16 v[8:11], a[0:3], a[128:131], 0
    ds_read_b128 a[8:11], v109 offset:0
    ds_read_b128 a[12:15], v109 offset:1024
    v_mfma_f32_16x16x32_bf16 v[24:27], a[4:7], a[128:131], 0
    ds_read_b128 a[144:147], v117 offset:0
    ds_read_b128 a[148:151], v117 offset:4096
    v_mfma_f32_16x16x32_bf16 v[12:15], a[0:3], a[132:135], 0
    ds_read_b128 a[152:155], v117 offset:8192
    ds_read_b128 a[156:159], v117 offset:12288
    v_mfma_f32_16x16x32_bf16 v[28:31], a[4:7], a[132:135], 0
    buffer_load_dwordx4 v102, s[8:11], s70 offen offset:2048 lds
    v_lshlrev_b32 v212, 16, v208
    v_lshlrev_b32 v213, 16, v209
    v_lshlrev_b32_e64 v210, 16, v210
    v_mfma_f32_16x16x32_bf16 v[16:19], a[0:3], a[136:139], 0
    buffer_load_dwordx4 v103, s[8:11], s70 offen offset:3072 lds
    v_mul_f32_e64 v210, s80, v210
    v_exp_f32_e64 v210, v210
    s_nop 0
    v_cvt_pk_bf16_f32 v210, v210, v210
    v_mfma_f32_16x16x32_bf16 v[32:35], a[4:7], a[136:139], 0
    s_add_u32 m0, s68, 16384
    s_mov_b32 s70, s35
    buffer_load_dwordx4 v104, s[12:15], s70 offen lds
    v_lshlrev_b32 v210, 16, v210
    v_mul_f32 v214, v210, v212
    v_mul_f32 v215, v210, v213
    v_mul_f32 v214, s80, v214
    v_mfma_f32_16x16x32_bf16 v[20:23], a[0:3], a[140:143], 0
    buffer_load_dwordx4 v105, s[12:15], s70 offen offset:1024 lds
    v_mul_f32 v215, s81, v215
    v_mov_b32 v220, v214
    v_mov_b32 v221, v215
    v_exp_f32 v220, v220
    v_mfma_f32_16x16x32_bf16 v[36:39], a[4:7], a[140:143], 0
    buffer_load_dwordx4 v106, s[12:15], s70 offen offset:2048 lds
    v_fract_f32 v221, v221
    v_cos_f32 v222, v221
    v_sin_f32 v223, v221
    v_mul_f32_e64 v156, v220, v222
    s_waitcnt lgkmcnt(0)
    v_mfma_f32_16x16x32_bf16 v[8:11], a[8:11], a[144:147], v[8:11]
    ds_read_b128 a[16:19], v110 offset:0
    ds_read_b128 a[20:23], v110 offset:1024
    v_mfma_f32_16x16x32_bf16 v[24:27], a[12:15], a[144:147], v[24:27]
    ds_read_b128 a[128:131], v118 offset:0
    ds_read_b128 a[132:135], v118 offset:4096
    v_mfma_f32_16x16x32_bf16 v[12:15], a[8:11], a[148:151], v[12:15]
    ds_read_b128 a[136:139], v118 offset:8192
    ds_read_b128 a[140:143], v118 offset:12288
    v_mfma_f32_16x16x32_bf16 v[28:31], a[12:15], a[148:151], v[28:31]
    buffer_load_dwordx4 v107, s[12:15], s70 offen offset:3072 lds
    v_mul_f32 v157, v220, v223
    v_subrev_f32 v220, 1.0, v156
    v_mul_f32 v221, v212, v212
    v_fmac_f32_e64 v221, v213, v213
    v_mfma_f32_16x16x32_bf16 v[16:19], a[8:11], a[152:155], v[16:19]
    s_add_u32 m0, s67, 131072
    s_mov_b32 s70, s74
    buffer_load_dwordx4 v96, s[8:11], s70 offen lds
    v_rcp_f32 v221, v221
    v_mul_f32 v222, v220, v212
    v_fmac_f32 v222, v157, v213
    v_mul_f32 v223, v157, v212
    v_mfma_f32_16x16x32_bf16 v[32:35], a[12:15], a[152:155], v[32:35]
    buffer_load_dwordx4 v97, s[8:11], s70 offen offset:1024 lds
    v_fma_f32 v223, -v220, v213, v223
    v_add_f32 v221, v221, v221
    v_mul_f32 v176, v222, v221
    v_mul_f32_e64 v177, v223, v221
    v_mfma_f32_16x16x32_bf16 v[20:23], a[8:11], a[156:159], v[20:23]
    buffer_load_dwordx4 v98, s[8:11], s70 offen offset:2048 lds
    v_mov_b32 v198, v176
    v_mov_b32 v199, v177
    s_nop 0
    v_permlane16_swap_b32 v176, v198
    v_mfma_f32_16x16x32_bf16 v[36:39], a[12:15], a[156:159], v[36:39]
    buffer_load_dwordx4 v99, s[8:11], s70 offen offset:3072 lds
    v_permlane16_swap_b32 v177, v199
    v_mov_b32 v178, v156
    v_mov_b32_e64 v179, v157
    s_nop 0
    s_waitcnt lgkmcnt(0)
    v_mfma_f32_16x16x32_bf16 v[8:11], a[16:19], a[128:131], v[8:11]
    ds_read_b128 a[24:27], v111 offset:0
    ds_read_b128 a[28:31], v111 offset:1024
    v_mfma_f32_16x16x32_bf16 v[24:27], a[20:23], a[128:131], v[24:27]
    ds_read_b128 a[144:147], v119 offset:0
    ds_read_b128 a[148:151], v119 offset:4096
    v_mfma_f32_16x16x32_bf16 v[12:15], a[16:19], a[132:135], v[12:15]
    ds_read_b128 a[152:155], v119 offset:8192
    ds_read_b128 a[156:159], v119 offset:12288
    v_mfma_f32_16x16x32_bf16 v[28:31], a[20:23], a[132:135], v[28:31]
    s_add_u32 m0, s67, 135168
    s_add_u32 s70, s74, 16384
    buffer_load_dwordx4 v100, s[8:11], s70 offen lds
    v_permlane16_swap_b32 v156, v178
    v_permlane16_swap_b32 v157, v179
    v_sub_f32 v158, 0, v157
    v_sub_f32 v180, 0, v179
    v_mfma_f32_16x16x32_bf16 v[16:19], a[16:19], a[136:139], v[16:19]
    buffer_load_dwordx4 v101, s[8:11], s70 offen offset:1024 lds
    v_mul_f32 v220, 0x41000000, v214
    v_mul_f32 v221, 0x41000000, v215
    v_exp_f32 v220, v220
    v_fract_f32 v221, v221
    v_mfma_f32_16x16x32_bf16 v[32:35], a[20:23], a[136:139], v[32:35]
    buffer_load_dwordx4 v102, s[8:11], s70 offen offset:2048 lds
    v_cos_f32 v222, v221
    v_sin_f32 v223, v221
    v_mul_f32 v159, v220, v222
    v_mul_f32 v160, v220, v223
    v_mfma_f32_16x16x32_bf16 v[20:23], a[16:19], a[140:143], v[20:23]
    buffer_load_dwordx4 v103, s[8:11], s70 offen offset:3072 lds
    v_mov_b32_e64 v181, v159
    v_mov_b32_e64 v182, v160
    s_nop 0
    v_permlane16_swap_b32 v159, v181
    v_mfma_f32_16x16x32_bf16 v[36:39], a[20:23], a[140:143], v[36:39]
    s_add_u32 m0, s68, 32768
    s_mov_b32 s70, s48
    buffer_load_dwordx4 v104, s[12:15], s70 offen lds
    v_permlane16_swap_b32 v160, v182
    v_mul_f32 v220, 0x41800000, v214
    v_mul_f32 v221, 0x41800000, v215
    v_exp_f32 v220, v220
    s_waitcnt lgkmcnt(0)
    buffer_load_dwordx4 v105, s[12:15], s70 offen offset:1024 lds
    buffer_load_dwordx4 v106, s[12:15], s70 offen offset:2048 lds
    buffer_load_dwordx4 v107, s[12:15], s70 offen offset:3072 lds
    s_waitcnt vmcnt(12)
    s_barrier
    v_mfma_f32_16x16x32_bf16 v[8:11], a[24:27], a[144:147], v[8:11]
    ds_read_b128 a[32:35], v108 offset:32768
    ds_read_b128 a[36:39], v108 offset:33792
    v_mfma_f32_16x16x32_bf16 v[24:27], a[28:31], a[144:147], v[24:27]
    ds_read_b128 a[128:131], v116 offset:16384
    ds_read_b128 a[132:135], v116 offset:20480
    v_mfma_f32_16x16x32_bf16 v[12:15], a[24:27], a[148:151], v[12:15]
    ds_read_b128 a[136:139], v116 offset:24576
    ds_read_b128 a[140:143], v116 offset:28672
    v_mfma_f32_16x16x32_bf16 v[28:31], a[28:31], a[148:151], v[28:31]
    v_fract_f32 v221, v221
    v_cos_f32 v222, v221
    v_sin_f32 v223, v221
    v_mul_f32 v161, v220, v222
    v_mfma_f32_16x16x32_bf16 v[16:19], a[24:27], a[152:155], v[16:19]
    v_mul_f32 v162, v220, v223
    v_mov_b32 v183, v161
    v_mov_b32 v184, v162
    s_nop 0
    v_mfma_f32_16x16x32_bf16 v[32:35], a[28:31], a[152:155], v[32:35]
    v_permlane16_swap_b32 v161, v183
    v_permlane16_swap_b32 v162, v184
    v_mul_f32 v220, 0x42000000, v214
    v_mul_f32 v221, 0x42000000, v215
    v_mfma_f32_16x16x32_bf16 v[20:23], a[24:27], a[156:159], v[20:23]
    v_exp_f32 v220, v220
    v_fract_f32 v221, v221
    v_cos_f32 v222, v221
    v_sin_f32 v223, v221
    v_mfma_f32_16x16x32_bf16 v[36:39], a[28:31], a[156:159], v[36:39]
    v_mul_f32 v163, v220, v222
    v_mul_f32 v164, v220, v223
    v_mov_b32 v185, v163
    v_mov_b32_e64 v186, v164
    s_waitcnt lgkmcnt(0)
    v_mfma_f32_16x16x32_bf16 v[8:11], a[32:35], a[128:131], v[8:11]
    ds_read_b128 a[40:43], v109 offset:32768
    ds_read_b128 a[44:47], v109 offset:33792
    v_mfma_f32_16x16x32_bf16 v[24:27], a[36:39], a[128:131], v[24:27]
    ds_read_b128 a[144:147], v117 offset:16384
    ds_read_b128 a[148:151], v117 offset:20480
    v_mfma_f32_16x16x32_bf16 v[12:15], a[32:35], a[132:135], v[12:15]
    ds_read_b128 a[152:155], v117 offset:24576
    ds_read_b128 a[156:159], v117 offset:28672
    v_mfma_f32_16x16x32_bf16 v[28:31], a[36:39], a[132:135], v[28:31]
    s_add_u32 m0, s67, 65536
    s_mov_b32 s70, s75
    buffer_load_dwordx4 v96, s[8:11], s70 offen lds
    s_nop 0
    v_permlane16_swap_b32 v163, v185
    v_permlane16_swap_b32 v164, v186
    v_mul_f32 v220, 0x44000000, v214
    v_mfma_f32_16x16x32_bf16 v[16:19], a[32:35], a[136:139], v[16:19]
    buffer_load_dwordx4 v97, s[8:11], s70 offen offset:1024 lds
    v_mul_f32 v221, 0x44000000, v215
    v_exp_f32 v220, v220
    v_fract_f32 v221, v221
    v_cos_f32_e64 v222, v221
    v_mfma_f32_16x16x32_bf16 v[32:35], a[36:39], a[136:139], v[32:35]
    buffer_load_dwordx4 v98, s[8:11], s70 offen offset:2048 lds
    v_sin_f32 v223, v221
    v_mul_f32 v173, v220, v222
    v_mul_f32 v174, v220, v223
    v_mov_b32 v195, v173
    v_mfma_f32_16x16x32_bf16 v[20:23], a[32:35], a[140:143], v[20:23]
    v_mov_b32 v196, v174
    s_nop 0
    v_permlane16_swap_b32 v173, v195
    v_permlane16_swap_b32 v174, v196
    v_mfma_f32_16x16x32_bf16 v[36:39], a[36:39], a[140:143], v[36:39]
    s_lshl_b32 s3, s6, 5
    v_cvt_f32_u32 v208, s3
    v_mul_f32 v220, v208, v214
    v_mul_f32 v221, v208, v215
    v_exp_f32 v220, v220
    s_waitcnt lgkmcnt(0)
    v_mfma_f32_16x16x32_bf16 v[8:11], a[40:43], a[144:147], v[8:11]
    ds_read_b128 a[48:51], v110 offset:32768
    ds_read_b128 a[52:55], v110 offset:33792
    v_mfma_f32_16x16x32_bf16 v[24:27], a[44:47], a[144:147], v[24:27]
    ds_read_b128 a[128:131], v118 offset:16384
    ds_read_b128 a[132:135], v118 offset:20480
    v_mfma_f32_16x16x32_bf16 v[12:15], a[40:43], a[148:151], v[12:15]
    ds_read_b128 a[136:139], v118 offset:24576
    ds_read_b128 a[140:143], v118 offset:28672
    v_mfma_f32_16x16x32_bf16 v[28:31], a[44:47], a[148:151], v[28:31]
    buffer_load_dwordx4 v99, s[8:11], s70 offen offset:3072 lds
    v_fract_f32 v221, v221
    v_cos_f32 v222, v221
    v_sin_f32 v223, v221
    v_mul_f32 v169, v220, v222
    v_mfma_f32_16x16x32_bf16 v[16:19], a[40:43], a[152:155], v[16:19]
    s_add_u32 m0, s67, 69632
    s_add_u32 s70, s75, 16384
    buffer_load_dwordx4 v100, s[8:11], s70 offen lds
    v_mul_f32 v170, v220, v223
    v_mov_b32 v191, v169
    v_mov_b32 v192, v170
    s_nop 0
    v_mfma_f32_16x16x32_bf16 v[32:35], a[44:47], a[152:155], v[32:35]
    buffer_load_dwordx4 v101, s[8:11], s70 offen offset:1024 lds
    v_permlane16_swap_b32 v169, v191
    v_permlane16_swap_b32 v170, v192
    v_mov_b32 v218, v214
    v_mov_b32 v219, v215
    v_mfma_f32_16x16x32_bf16 v[20:23], a[40:43], a[156:159], v[20:23]
    s_nop 0
    v_permlane16_swap_b32 v214, v218
    v_permlane16_swap_b32 v215, v219
    v_cvt_f32_u32 v208, v3
    v_mfma_f32_16x16x32_bf16 v[36:39], a[44:47], a[156:159], v[36:39]
    v_mul_f32 v209, 0x41000000, v208
    v_mul_f32 v210, 0x43000000, v208
    v_mul_f32_e64 v220, v209, v214
    v_mul_f32 v221, v209, v215
    s_waitcnt lgkmcnt(0)
    v_mfma_f32_16x16x32_bf16 v[8:11], a[48:51], a[128:131], v[8:11]
    ds_read_b128 a[56:59], v111 offset:32768
    ds_read_b128 a[60:63], v111 offset:33792
    v_mfma_f32_16x16x32_bf16 v[24:27], a[52:55], a[128:131], v[24:27]
    ds_read_b128 a[144:147], v119 offset:16384
    ds_read_b128 a[148:151], v119 offset:20480
    v_mfma_f32_16x16x32_bf16 v[12:15], a[48:51], a[132:135], v[12:15]
    ds_read_b128 a[152:155], v119 offset:24576
    ds_read_b128 a[156:159], v119 offset:28672
    v_mfma_f32_16x16x32_bf16 v[28:31], a[52:55], a[132:135], v[28:31]
    buffer_load_dwordx4 v102, s[8:11], s70 offen offset:2048 lds
    v_exp_f32 v220, v220
    v_fract_f32 v221, v221
    v_cos_f32 v222, v221
    v_sin_f32 v223, v221
    v_mfma_f32_16x16x32_bf16 v[16:19], a[48:51], a[136:139], v[16:19]
    buffer_load_dwordx4 v103, s[8:11], s70 offen offset:3072 lds
    v_mul_f32 v165, v220, v222
    v_mul_f32 v166, v220, v223
    v_mul_f32 v224, v209, v218
    v_mul_f32 v225, v209, v219
    v_mfma_f32_16x16x32_bf16 v[32:35], a[52:55], a[136:139], v[32:35]
    s_add_u32 m0, s68, 49152
    s_mov_b32 s70, s49
    buffer_load_dwordx4 v104, s[12:15], s70 offen lds
    v_exp_f32 v224, v224
    v_fract_f32 v225, v225
    v_cos_f32 v226, v225
    v_sin_f32_e64 v227, v225
    v_mfma_f32_16x16x32_bf16 v[20:23], a[48:51], a[140:143], v[20:23]
    v_mul_f32 v187, v224, v226
    v_mul_f32 v188, v224, v227
    v_mul_f32 v220, v210, v214
    v_mul_f32 v221, v210, v215
    v_mfma_f32_16x16x32_bf16 v[36:39], a[52:55], a[140:143], v[36:39]
    v_exp_f32 v220, v220
    v_fract_f32 v221, v221
    v_cos_f32 v222, v221
    v_sin_f32_e64 v223, v221
    s_waitcnt lgkmcnt(0)
    buffer_load_dwordx4 v105, s[12:15], s70 offen offset:1024 lds
    buffer_load_dwordx4 v106, s[12:15], s70 offen offset:2048 lds
    buffer_load_dwordx4 v107, s[12:15], s70 offen offset:3072 lds
    s_waitcnt vmcnt(12)
    s_barrier
    v_mfma_f32_16x16x32_bf16 v[8:11], a[56:59], a[144:147], v[8:11]
    ds_read_b128 a[64:67], v112 offset:0
    ds_read_b128 a[68:71], v112 offset:1024
    v_mfma_f32_16x16x32_bf16 v[24:27], a[60:63], a[144:147], v[24:27]
    ds_read_b128 a[128:131], v116 offset:32768
    ds_read_b128 a[132:135], v116 offset:36864
    v_mfma_f32_16x16x32_bf16 v[12:15], a[56:59], a[148:151], v[12:15]
    ds_read_b128 a[136:139], v116 offset:40960
    ds_read_b128 a[140:143], v116 offset:45056
    v_mfma_f32_16x16x32_bf16 v[28:31], a[60:63], a[148:151], v[28:31]
    v_mul_f32 v171, v220, v222
    v_mul_f32 v172, v220, v223
    v_mul_f32 v224, v210, v218
    v_mul_f32 v225, v210, v219
    v_mfma_f32_16x16x32_bf16 v[16:19], a[56:59], a[152:155], v[16:19]
    v_exp_f32 v224, v224
    v_fract_f32 v225, v225
    v_cos_f32 v226, v225
    v_sin_f32 v227, v225
    v_mfma_f32_16x16x32_bf16 v[32:35], a[60:63], a[152:155], v[32:35]
    v_mul_f32 v193, v224, v226
    v_mul_f32 v194, v224, v227
    v_cmp_eq_u32 vcc, 3, v3
    v_cmp_eq_u32 s[82:83], 2, v3
    v_mfma_f32_16x16x32_bf16 v[20:23], a[56:59], a[156:159], v[20:23]
    v_and_b32 v4, 1, v3
    v_cvt_f32_u32_e64 v175, v4
    v_cndmask_b32 v5, 0, 1.0, s[82:83]
    v_cndmask_b32_e64 v167, v5, v159, vcc
    v_mfma_f32_16x16x32_bf16 v[36:39], a[60:63], a[156:159], v[36:39]
    v_cndmask_b32_e64 v168, 0, v160, vcc
    v_cndmask_b32 v189, v5, v181, vcc
    v_cndmask_b32_e64 v190, 0, v182, vcc
    s_waitcnt lgkmcnt(0)
    v_mfma_f32_16x16x32_bf16 v[8:11], a[64:67], a[128:131], v[8:11]
    ds_read_b128 a[72:75], v113 offset:0
    ds_read_b128 a[76:79], v113 offset:1024
    v_mfma_f32_16x16x32_bf16 v[24:27], a[68:71], a[128:131], v[24:27]
    ds_read_b128 a[144:147], v117 offset:32768
    ds_read_b128 a[148:151], v117 offset:36864
    v_mfma_f32_16x16x32_bf16 v[12:15], a[64:67], a[132:135], v[12:15]
    ds_read_b128 a[152:155], v117 offset:40960
    ds_read_b128 a[156:159], v117 offset:45056
    v_mfma_f32_16x16x32_bf16 v[28:31], a[68:71], a[132:135], v[28:31]
    s_add_u32 m0, s67, 0
    s_mul_i32 s70, s5, 224
    buffer_load_dword v253, s[60:63], s70 offen lds
    s_add_u32 s3, s66, 0
    s_add_u32 s7, s69, 0
    s_add_u32 s71, s65, 0
    s_add_u32 s82, s65, 65536
    s_mov_b32 s48, 0x20000
    s_bitcmp1_b32 s6, 0
    s_cselect_b32 s12, s28, s26
    s_cselect_b32 s13, s29, s27
    s_cselect_b32 s72, s26, s28
    s_cselect_b32 s73, s27, s29
    s_cmp_gt_i32 s90, 0
    s_cselect_b32 s12, s12, s40
    s_cselect_b32 s13, s13, s41
    s_cselect_b32 s72, s72, s40
    s_cselect_b32 s73, s73, s41
    s_cselect_b32 s34, s3, s71
    s_cselect_b32 s35, s7, s82
    s_cselect_b32 s48, 128, s48
    s_cselect_b64 vcc, -1, 0
    s_mov_b32 s14, 0x1c0000
    s_mov_b32 s15, 0x20000
    s_mov_b32 s74, 0x1c0000
    v_mfma_f32_16x16x32_bf16 v[16:19], a[64:67], a[136:139], v[16:19]
    s_add_u32 m0, s67, 98304
    s_mov_b32 s70, s85
    buffer_load_dwordx4 v120, s[52:55], s70 offen lds
    s_mov_b32 s75, 0x20000
    v_add_u32_e64 v4, 0, v232
    v_add_u32_e64 v5, 0, v231
    v_cndmask_b32_e64 v246, v5, v4, vcc
    v_mfma_f32_16x16x32_bf16 v[32:35], a[68:71], a[136:139], v[32:35]
    buffer_load_dwordx4 v121, s[52:55], s70 offen offset:1024 lds
    v_add_u32 v4, 7168, v233
    v_add_u32 v5, 7168, v231
    v_cndmask_b32_e64 v247, v5, v4, vcc
    v_add_u32 v4, 14336, v232
    v_mfma_f32_16x16x32_bf16 v[20:23], a[64:67], a[140:143], v[20:23]
    v_add_u32 v5, 14336, v231
    v_cndmask_b32_e64 v248, v5, v4, vcc
    v_add_u32 v4, 21504, v233
    v_add_u32 v5, 21504, v231
    v_mfma_f32_16x16x32_bf16 v[36:39], a[68:71], a[140:143], v[36:39]
    v_cndmask_b32 v249, v5, v4, vcc
    s_waitcnt lgkmcnt(0)
    v_mfma_f32_16x16x32_bf16 v[8:11], a[72:75], a[144:147], v[8:11]
    ds_read_b128 a[80:83], v114 offset:0
    ds_read_b128 a[84:87], v114 offset:1024
    v_mfma_f32_16x16x32_bf16 v[24:27], a[76:79], a[144:147], v[24:27]
    ds_read_b128 a[128:131], v118 offset:32768
    ds_read_b128 a[132:135], v118 offset:36864
    v_mfma_f32_16x16x32_bf16 v[12:15], a[72:75], a[148:151], v[12:15]
    ds_read_b128 a[136:139], v118 offset:40960
    ds_read_b128 a[140:143], v118 offset:45056
    v_mfma_f32_16x16x32_bf16 v[28:31], a[76:79], a[148:151], v[28:31]
    buffer_load_dwordx4 v122, s[52:55], s70 offen offset:2048 lds
    v_mfma_f32_16x16x32_bf16 v[16:19], a[72:75], a[152:155], v[16:19]
    buffer_load_dwordx4 v123, s[52:55], s70 offen offset:3072 lds
    v_mfma_f32_16x16x32_bf16 v[32:35], a[76:79], a[152:155], v[32:35]
    s_add_u32 m0, s67, 102400
    s_mov_b32 s70, s85
    buffer_load_dwordx4 v124, s[52:55], s70 offen lds
    v_mfma_f32_16x16x32_bf16 v[20:23], a[72:75], a[156:159], v[20:23]
    v_mfma_f32_16x16x32_bf16 v[36:39], a[76:79], a[156:159], v[36:39]
    s_waitcnt lgkmcnt(0)
    v_mfma_f32_16x16x32_bf16 v[8:11], a[80:83], a[128:131], v[8:11]
    ds_read_b128 a[88:91], v115 offset:0
    ds_read_b128 a[92:95], v115 offset:1024
    v_mfma_f32_16x16x32_bf16 v[24:27], a[84:87], a[128:131], v[24:27]
    ds_read_b128 a[144:147], v119 offset:32768
    ds_read_b128 a[148:151], v119 offset:36864
    v_mfma_f32_16x16x32_bf16 v[12:15], a[80:83], a[132:135], v[12:15]
    ds_read_b128 a[152:155], v119 offset:40960
    ds_read_b128 a[156:159], v119 offset:45056
    v_mfma_f32_16x16x32_bf16 v[28:31], a[84:87], a[132:135], v[28:31]
    buffer_load_dwordx4 v125, s[52:55], s70 offen offset:1024 lds
    v_mfma_f32_16x16x32_bf16 v[16:19], a[80:83], a[136:139], v[16:19]
    buffer_load_dwordx4 v126, s[52:55], s70 offen offset:2048 lds
    v_mfma_f32_16x16x32_bf16 v[32:35], a[84:87], a[136:139], v[32:35]
    buffer_load_dwordx4 v127, s[52:55], s70 offen offset:3072 lds
    v_mfma_f32_16x16x32_bf16 v[20:23], a[80:83], a[140:143], v[20:23]
    v_mfma_f32_16x16x32_bf16 v[36:39], a[84:87], a[140:143], v[36:39]
    s_waitcnt lgkmcnt(0)
    s_waitcnt vmcnt(9)
    s_barrier
    v_mfma_f32_16x16x32_bf16 v[8:11], a[88:91], a[144:147], v[8:11]
    ds_read_b128 a[96:99], v108 offset:0
    ds_read_b128 a[100:103], v108 offset:1024
    v_mfma_f32_16x16x32_bf16 v[24:27], a[92:95], a[144:147], v[24:27]
    ds_read_b128 a[128:131], v116 offset:49152
    ds_read_b128 a[132:135], v116 offset:53248
    v_mfma_f32_16x16x32_bf16 v[12:15], a[88:91], a[148:151], v[12:15]
    ds_read_b128 a[136:139], v116 offset:57344
    ds_read_b128 a[140:143], v116 offset:61440
    v_mfma_f32_16x16x32_bf16 v[28:31], a[92:95], a[148:151], v[28:31]
    v_mfma_f32_16x16x32_bf16 v[16:19], a[88:91], a[152:155], v[16:19]
    v_mfma_f32_16x16x32_bf16 v[32:35], a[92:95], a[152:155], v[32:35]
    v_mfma_f32_16x16x32_bf16 v[20:23], a[88:91], a[156:159], v[20:23]
    v_mfma_f32_16x16x32_bf16 v[36:39], a[92:95], a[156:159], v[36:39]
    s_waitcnt lgkmcnt(0)
    v_mfma_f32_16x16x32_bf16 v[8:11], a[96:99], a[128:131], v[8:11]
    ds_read_b128 a[104:107], v109 offset:0
    ds_read_b128 a[108:111], v109 offset:1024
    v_mfma_f32_16x16x32_bf16 v[24:27], a[100:103], a[128:131], v[24:27]
    ds_read_b128 a[144:147], v117 offset:49152
    ds_read_b128 a[148:151], v117 offset:53248
    v_mfma_f32_16x16x32_bf16 v[12:15], a[96:99], a[132:135], v[12:15]
    ds_read_b128 a[152:155], v117 offset:57344
    ds_read_b128 a[156:159], v117 offset:61440
    v_mfma_f32_16x16x32_bf16 v[28:31], a[100:103], a[132:135], v[28:31]
    s_add_u32 m0, s67, 131072
    s_mov_b32 s70, s86
    buffer_load_dwordx4 v120, s[52:55], s70 offen lds
    s_add_u32 s3, s67, 0
    v_lshl_add_u32 v4, v3, 3, s3
    s_and_b32 s3, s5, 1
    s_lshl_b32 s7, s3, 5
    v_add_u32 v5, s7, v4
    s_mul_i32 s7, s3, 192
    s_sub_u32 s7, 192, s7
    v_add_u32_e64 v6, s7, v4
    s_waitcnt vmcnt(9)
    ds_read_b64 v[216:217], v5 offset:0
    ds_read_b64 v[218:219], v5 offset:32
    v_mfma_f32_16x16x32_bf16 v[16:19], a[96:99], a[136:139], v[16:19]
    buffer_load_dwordx4 v121, s[52:55], s70 offen offset:1024 lds
    ds_read_b64 v[220:221], v5 offset:64
    ds_read_b64 v[222:223], v5 offset:96
    ds_read_b64 v[224:225], v5 offset:128
    ds_read_b64 v[226:227], v5 offset:160
    v_mfma_f32_16x16x32_bf16 v[32:35], a[100:103], a[136:139], v[32:35]
    ds_read_b64 v[228:229], v6
    s_waitcnt lgkmcnt(0)
    v_lshlrev_b32 v128, 16, v216
    v_and_b32 v129, 0xffff0000, v216
    v_mfma_f32_16x16x32_bf16 v[20:23], a[96:99], a[140:143], v[20:23]
    v_lshlrev_b32_e64 v130, 16, v217
    v_and_b32 v131, 0xffff0000, v217
    v_lshlrev_b32_e64 v132, 16, v218
    v_and_b32 v133, 0xffff0000, v218
    v_mfma_f32_16x16x32_bf16 v[36:39], a[100:103], a[140:143], v[36:39]
    v_lshlrev_b32_e64 v134, 16, v219
    v_and_b32 v135, 0xffff0000, v219
    v_lshlrev_b32 v136, 16, v220
    v_and_b32 v137, 0xffff0000, v220
    s_waitcnt lgkmcnt(0)
    v_mfma_f32_16x16x32_bf16 v[8:11], a[104:107], a[144:147], v[8:11]
    ds_read_b128 a[112:115], v110 offset:0
    ds_read_b128 a[116:119], v110 offset:1024
    v_mfma_f32_16x16x32_bf16 v[24:27], a[108:111], a[144:147], v[24:27]
    ds_read_b128 a[128:131], v118 offset:49152
    ds_read_b128 a[132:135], v118 offset:53248
    v_mfma_f32_16x16x32_bf16 v[12:15], a[104:107], a[148:151], v[12:15]
    ds_read_b128 a[136:139], v118 offset:57344
    ds_read_b128 a[140:143], v118 offset:61440
    v_mfma_f32_16x16x32_bf16 v[28:31], a[108:111], a[148:151], v[28:31]
    buffer_load_dwordx4 v122, s[52:55], s70 offen offset:2048 lds
    v_lshlrev_b32 v138, 16, v221
    v_and_b32 v139, 0xffff0000, v221
    v_lshlrev_b32 v140, 16, v222
    v_and_b32 v141, 0xffff0000, v222
    v_mfma_f32_16x16x32_bf16 v[16:19], a[104:107], a[152:155], v[16:19]
    buffer_load_dwordx4 v123, s[52:55], s70 offen offset:3072 lds
    v_lshlrev_b32 v142, 16, v223
    v_and_b32 v143, 0xffff0000, v223
    v_lshlrev_b32 v144, 16, v224
    v_and_b32 v145, 0xffff0000, v224
    v_mfma_f32_16x16x32_bf16 v[32:35], a[108:111], a[152:155], v[32:35]
    v_lshlrev_b32_e64 v146, 16, v225
    v_and_b32 v147, 0xffff0000, v225
    v_lshlrev_b32_e64 v148, 16, v226
    v_and_b32 v149, 0xffff0000, v226
    v_mfma_f32_16x16x32_bf16 v[20:23], a[104:107], a[156:159], v[20:23]
    v_lshlrev_b32_e64 v150, 16, v227
    v_and_b32 v151, 0xffff0000, v227
    v_lshlrev_b32_e64 v152, 16, v228
    v_and_b32 v153, 0xffff0000, v228
    v_mfma_f32_16x16x32_bf16 v[36:39], a[108:111], a[156:159], v[36:39]
    v_lshlrev_b32 v154, 16, v229
    v_and_b32 v155, 0xffff0000, v229
    v_add_u32 v224, 98304, v234
    v_add_u32 v230, 98304, v239
    s_waitcnt lgkmcnt(0)
    v_mfma_f32_16x16x32_bf16 v[8:11], a[112:115], a[128:131], v[8:11]
    ds_read_b128 a[120:123], v111 offset:0
    ds_read_b128 a[124:127], v111 offset:1024
    v_mfma_f32_16x16x32_bf16 v[24:27], a[116:119], a[128:131], v[24:27]
    ds_read_b128 a[144:147], v119 offset:49152
    ds_read_b128 a[148:151], v119 offset:53248
    v_mfma_f32_16x16x32_bf16 v[12:15], a[112:115], a[132:135], v[12:15]
    ds_read_b128 a[152:155], v119 offset:57344
    ds_read_b128 a[156:159], v119 offset:61440
    v_mfma_f32_16x16x32_bf16 v[28:31], a[116:119], a[132:135], v[28:31]
    s_add_u32 m0, s67, 135168
    s_mov_b32 s70, s86
    buffer_load_dwordx4 v124, s[52:55], s70 offen lds
    v_add_u32 v225, 98304, v235
    v_add_u32 v226, 98304, v236
    v_add_u32 v227, 98304, v237
    v_add_u32 v228, 98304, v238
    v_mfma_f32_16x16x32_bf16 v[16:19], a[112:115], a[136:139], v[16:19]
    buffer_load_dwordx4 v125, s[52:55], s70 offen offset:1024 lds
    v_mfma_f32_16x16x32_bf16 v[32:35], a[116:119], a[136:139], v[32:35]
    v_mfma_f32_16x16x32_bf16 v[20:23], a[112:115], a[140:143], v[20:23]
    v_mfma_f32_16x16x32_bf16 v[36:39], a[116:119], a[140:143], v[36:39]
    s_waitcnt lgkmcnt(0)
    v_mfma_f32_16x16x32_bf16 v[8:11], a[120:123], a[144:147], v[8:11]
    v_mfma_f32_16x16x32_bf16 v[24:27], a[124:127], a[144:147], v[24:27]
    v_mfma_f32_16x16x32_bf16 v[12:15], a[120:123], a[148:151], v[12:15]
    v_mfma_f32_16x16x32_bf16 v[28:31], a[124:127], a[148:151], v[28:31]
    buffer_load_dwordx4 v126, s[52:55], s70 offen offset:2048 lds
    v_mfma_f32_16x16x32_bf16 v[16:19], a[120:123], a[152:155], v[16:19]
    buffer_load_dwordx4 v127, s[52:55], s70 offen offset:3072 lds
    v_mfma_f32_16x16x32_bf16 v[32:35], a[124:127], a[152:155], v[32:35]
    v_mfma_f32_16x16x32_bf16 v[20:23], a[120:123], a[156:159], v[20:23]
    v_mfma_f32_16x16x32_bf16 v[36:39], a[124:127], a[156:159], v[36:39]
    s_lshl_b32 s3, s2, 2
    s_add_u32 s3, s3, s6
    s_sub_u32 s7, s3, 640
    s_sub_u32 s71, s3, 832
    s_cmp_lt_u32 s3, 832
    s_cselect_b32 s60, s26, s28
    s_cselect_b32 s61, s27, s29
    s_cselect_b32 s7, s7, s71
    s_mov_b32 s62, 0x80000
    s_cmp_lt_u32 s3, 640
    s_cselect_b32 s60, s40, s60
    s_cselect_b32 s61, s41, s61
    s_cselect_b32 s7, s3, s7
    s_cselect_b32 s62, 0x1c0000, s62
    s_and_b32 s61, s61, 0xffff
    s_mov_b32 s63, 0x20000
    s_mul_i32 s7, s7, 2944
    v_lshlrev_b32 v4, 7, v1
    v_add_u32 v4, s7, v4
    v_cmp_gt_u32 vcc, 23, v1
    v_mov_b32 v5, 0x7fffff00
    s_nop 0
    v_cndmask_b32 v4, v5, v4, vcc
    buffer_load_dword v253, v4, s[60:63], 0 offen
    s_nop 3
    v_fma_f32 v98, v156, v8, v9
    v_fma_f32 v99, v156, v16, v17
    v_fmac_f32 v98, v158, v16
    v_fmac_f32 v99, v157, v8
    v_fma_f32 v102, v178, v12, v13
    v_fma_f32 v103, v178, v20, v21
    v_fmac_f32 v102, v180, v20
    v_fmac_f32 v103, v179, v12
    v_fma_f32 v96, v156, v98, v10
    v_fma_f32 v97, v156, v99, v18
    v_fmac_f32 v96, v158, v99
    v_fmac_f32 v97, v157, v98
    v_fma_f32 v100, v178, v102, v14
    v_fma_f32 v101, v178, v103, v22
    v_fmac_f32 v100, v180, v103
    v_fmac_f32 v101, v179, v102
    s_add_u32 m0, s67, 0
    s_mov_b32 s70, s87
    buffer_load_dwordx4 v120, s[52:55], s70 offen lds
    v_fma_f32 v98, v156, v96, v11
    v_fma_f32 v99, v156, v97, v19
    v_fmac_f32 v98, v158, v97
    v_fmac_f32 v99, v157, v96
    v_fma_f32 v102, v178, v100, v15
    v_fma_f32 v103, v178, v101, v23
    v_fmac_f32 v102, v180, v101
    v_fmac_f32 v103, v179, v100
    v_fma_f32 v96, v156, v98, v24
    v_fma_f32 v97, v156, v99, v32
    v_fmac_f32 v96, v158, v99
    v_fmac_f32 v97, v157, v98
    v_fma_f32 v100, v178, v102, v28
    v_fma_f32 v101, v178, v103, v36
    v_fmac_f32 v100, v180, v103
    v_fmac_f32 v101, v179, v102
    buffer_load_dwordx4 v121, s[52:55], s70 offen offset:1024 lds
    v_fma_f32 v98, v156, v96, v25
    v_fma_f32 v99, v156, v97, v33
    v_fmac_f32 v98, v158, v97
    v_fmac_f32 v99, v157, v96
    v_fma_f32 v102, v178, v100, v29
    v_fma_f32 v103, v178, v101, v37
    v_fmac_f32 v102, v180, v101
    v_fmac_f32 v103, v179, v100
    v_fma_f32 v96, v156, v98, v26
    v_fma_f32 v97, v156, v99, v34
    v_fmac_f32 v96, v158, v99
    v_fmac_f32 v97, v157, v98
    v_fma_f32 v100, v178, v102, v30
    v_fma_f32 v101, v178, v103, v38
    v_fmac_f32 v100, v180, v103
    v_fmac_f32 v101, v179, v102
    buffer_load_dwordx4 v122, s[52:55], s70 offen offset:2048 lds
    v_fma_f32 v98, v156, v96, v27
    v_fma_f32 v99, v156, v97, v35
    v_fmac_f32 v98, v158, v97
    v_fmac_f32 v99, v157, v96
    v_fma_f32 v102, v178, v100, v31
    v_fma_f32 v103, v178, v101, v39
    v_fmac_f32 v102, v180, v101
    v_fmac_f32 v103, v179, v100
    v_mov_b32 v104, v98
    v_mov_b32 v108, v98
    v_mov_b32 v105, v99
    v_mov_b32 v109, v99
    v_mov_b32 v106, v102
    v_mov_b32 v110, v102
    v_mov_b32 v107, v103
    v_mov_b32 v111, v103
    s_nop 1
    v_permlane16_swap_b32 v108, v104
    v_permlane16_swap_b32 v109, v105
    v_permlane16_swap_b32 v110, v106
    v_permlane16_swap_b32 v111, v107
    s_nop 0
    v_fmac_f32 v104, v159, v108
    v_fmac_f32 v105, v159, v109
    v_fma_f32 v104, -v160, v109, v104
    v_fmac_f32 v105, v160, v108
    v_fmac_f32 v106, v181, v110
    v_fmac_f32 v107, v181, v111
    v_fma_f32 v106, -v182, v111, v106
    v_fmac_f32 v107, v182, v110
    buffer_load_dwordx4 v123, s[52:55], s70 offen offset:3072 lds
    v_mov_b32 v112, v104
    v_mov_b32 v113, v105
    v_mov_b32 v114, v106
    v_mov_b32 v115, v107
    s_nop 1
    v_permlane32_swap_b32 v112, v104
    v_permlane32_swap_b32 v113, v105
    v_permlane32_swap_b32 v114, v106
    v_permlane32_swap_b32 v115, v107
    s_nop 0
    v_fmac_f32 v104, v161, v112
    v_fmac_f32 v105, v161, v113
    v_fma_f32 v104, -v162, v113, v104
    v_fmac_f32 v105, v162, v112
    v_fmac_f32 v106, v183, v114
    v_fmac_f32 v107, v183, v115
    v_fma_f32 v106, -v184, v115, v106
    v_fmac_f32 v107, v184, v114
    s_add_u32 m0, s67, 4096
    s_mov_b32 s70, s87
    buffer_load_dwordx4 v124, s[52:55], s70 offen lds
    v_lshlrev_b32 v4, 4, v2
    s_lshl_b32 s3, s6, 8
    s_add_u32 s3, s3, 32768
    v_add_u32 v5, s3, v4
    v_add_u32 v4, 32768, v4
    ds_write_b128 v5, v[104:107]
    v_mul_f32 v200, v175, v108
    v_mul_f32 v201, v175, v109
    v_fmac_f32 v200, v167, v112
    v_fmac_f32 v201, v167, v113
    v_fma_f32 v200, -v168, v113, v200
    v_fmac_f32 v201, v168, v112
    v_mul_f32 v202, v175, v110
    v_mul_f32 v203, v175, v111
    v_fmac_f32 v202, v189, v114
    v_fmac_f32_e64 v203, v189, v115
    v_fma_f32 v202, -v190, v115, v202
    v_fmac_f32 v203, v190, v114
    s_waitcnt lgkmcnt(0)
    s_waitcnt vmcnt(14)
    s_barrier
    ds_read_b128 v[96:99], v4 offset:0
    ds_read_b128 v[100:103], v4 offset:256
    ds_read_b128 v[104:107], v4 offset:512
    ds_read_b128 v[108:111], v4 offset:768
    ds_read_b64_tr_b16 a[128:129], v240 offset:0
    ds_read_b64_tr_b16 a[130:131], v240 offset:4096
    ds_read_b64_tr_b16 a[132:133], v241 offset:0
    ds_read_b64_tr_b16 a[134:135], v241 offset:4096
    ds_read_b64_tr_b16 a[136:137], v242 offset:0
    ds_read_b64_tr_b16 a[138:139], v242 offset:4096
    ds_read_b64_tr_b16 a[140:141], v243 offset:0
    ds_read_b64_tr_b16 a[142:143], v243 offset:4096
    ds_read_b64_tr_b16 a[144:145], v244 offset:0
    ds_read_b64_tr_b16 a[146:147], v244 offset:4096
    ds_read_b64_tr_b16 a[148:149], v245 offset:0
    ds_read_b64_tr_b16 a[150:151], v245 offset:4096
    ds_read_b64_tr_b16 a[152:153], v250 offset:0
    ds_read_b64_tr_b16 a[154:155], v250 offset:4096
    s_lshl_b32 s3, s4, 9
    v_lshlrev_b32 v4, 5, v2
    v_lshl_add_u32 v4, v3, 4, v4
    v_add_u32 v4, s3, v4
    s_cmp_eq_u32 s6, 3
    s_cselect_b32 s3, 32, 0
    v_mov_b32 v5, 0x7fffff00
    v_cmp_gt_u32 vcc, s3, v1
    v_cmp_eq_u32 s[82:83], 1, v3
    v_mov_b32 v114, s97
    v_mov_b32 v115, s97
    v_cndmask_b32 v4, v5, v4, vcc
    s_waitcnt lgkmcnt(14)
    v_fmac_f32 v100, v163, v96
    v_fmac_f32 v101, v163, v97
    v_fma_f32 v100, -v164, v97, v100
    v_fmac_f32 v101, v164, v96
    v_fmac_f32 v102, v185, v98
    v_fmac_f32 v103, v185, v99
    v_fma_f32 v102, -v186, v99, v102
    v_fmac_f32 v103, v186, v98
    v_fmac_f32 v104, v163, v100
    v_fmac_f32 v105, v163, v101
    v_fma_f32 v104, -v164, v101, v104
    v_fmac_f32 v105, v164, v100
    v_fmac_f32 v106, v185, v102
    v_fmac_f32 v107, v185, v103
    v_fma_f32 v106, -v186, v103, v106
    v_fmac_f32 v107, v186, v102
    v_fmac_f32 v108, v163, v104
    v_fmac_f32 v109, v163, v105
    v_fma_f32 v108, -v164, v105, v108
    v_fmac_f32 v109, v164, v104
    v_fmac_f32 v110, v185, v106
    v_fmac_f32 v111, v185, v107
    v_fma_f32 v110, -v186, v107, v110
    v_fmac_f32 v111, v186, v106
    buffer_load_dwordx4 v125, s[52:55], s70 offen offset:1024 lds
    buffer_load_dwordx4 v126, s[52:55], s70 offen offset:2048 lds
    buffer_load_dwordx4 v127, s[52:55], s70 offen offset:3072 lds
    v_cndmask_b32 v112, v108, v110, s[82:83]
    v_cndmask_b32 v113, v109, v111, s[82:83]
    buffer_store_dwordx4 v[112:115], v4, s[76:79], 0 offen sc1
    v_mov_b32 v204, 0
    v_mov_b32 v205, 0
    v_mov_b32 v206, 0
    v_mov_b32 v207, 0
    s_cmp_lt_u32 s6, 1
    s_cbranch_scc1 L_win_1
    v_mov_b32 v204, v96
    v_mov_b32 v205, v97
    v_mov_b32 v206, v98
    v_mov_b32 v207, v99
    s_cmp_lt_u32 s6, 2
    s_cbranch_scc1 L_win_1
    v_mov_b32 v204, v100
    v_mov_b32 v205, v101
    v_mov_b32 v206, v102
    v_mov_b32 v207, v103
    s_cmp_lt_u32 s6, 3
    s_cbranch_scc1 L_win_1
    v_mov_b32_e64 v204, v104
    v_mov_b32_e64 v205, v105
    v_mov_b32_e64 v206, v106
    v_mov_b32_e64 v207, v107
L_win_1:
    s_waitcnt lgkmcnt(0)
    v_mfma_f32_16x16x32_bf16 v[40:43], a[128:131], a[0:3], v[128:131]
    ds_read_b64_tr_b16 a[156:157], v240 offset:8192
    s_add_u32 m0, s67, 65536
    v_mfma_f32_16x16x32_bf16 v[44:47], a[128:131], a[4:7], v[128:131]
    ds_read_b64_tr_b16 a[158:159], v240 offset:12288
    s_mov_b32 s70, s88
    v_mfma_f32_16x16x32_bf16 v[48:51], a[132:135], a[0:3], v[132:135]
    ds_read_b64_tr_b16 a[160:161], v241 offset:8192
    buffer_load_dwordx4 v120, s[52:55], s70 offen lds
    v_mfma_f32_16x16x32_bf16 v[52:55], a[132:135], a[4:7], v[132:135]
    ds_read_b64_tr_b16 a[162:163], v241 offset:12288
    v_mfma_f32_16x16x32_bf16 v[56:59], a[136:139], a[0:3], v[136:139]
    ds_read_b64_tr_b16 a[164:165], v242 offset:8192
    v_mfma_f32_16x16x32_bf16 v[60:63], a[136:139], a[4:7], v[136:139]
    ds_read_b64_tr_b16 a[166:167], v242 offset:12288
    v_mfma_f32_16x16x32_bf16 v[64:67], a[140:143], a[0:3], v[140:143]
    ds_read_b64_tr_b16 a[168:169], v243 offset:8192
    v_mfma_f32_16x16x32_bf16 v[68:71], a[140:143], a[4:7], v[140:143]
    ds_read_b64_tr_b16 a[170:171], v243 offset:12288
    buffer_load_dwordx4 v121, s[52:55], s70 offen offset:1024 lds
    v_mfma_f32_16x16x32_bf16 v[72:75], a[144:147], a[0:3], v[144:147]
    ds_read_b64_tr_b16 a[172:173], v244 offset:8192
    v_mfma_f32_16x16x32_bf16 v[76:79], a[144:147], a[4:7], v[144:147]
    ds_read_b64_tr_b16 a[174:175], v244 offset:12288
    v_mfma_f32_16x16x32_bf16 v[80:83], a[148:151], a[0:3], v[148:151]
    ds_read_b64_tr_b16 a[176:177], v245 offset:8192
    v_mfma_f32_16x16x32_bf16 v[84:87], a[148:151], a[4:7], v[148:151]
    ds_read_b64_tr_b16 a[178:179], v245 offset:12288
    v_mfma_f32_16x16x32_bf16 v[88:91], a[152:155], a[0:3], v[152:155]
    ds_read_b64_tr_b16 a[180:181], v250 offset:8192
    buffer_load_dwordx4 v122, s[52:55], s70 offen offset:2048 lds
    v_mfma_f32_16x16x32_bf16 v[92:95], a[152:155], a[4:7], v[152:155]
    ds_read_b64_tr_b16 a[182:183], v250 offset:12288
    s_waitcnt lgkmcnt(4)
    v_mfma_f32_16x16x32_bf16 v[40:43], a[156:159], a[8:11], v[40:43]
    ds_read_b64_tr_b16 a[128:129], v240 offset:16384
    v_mfma_f32_16x16x32_bf16 v[44:47], a[156:159], a[12:15], v[44:47]
    ds_read_b64_tr_b16 a[130:131], v240 offset:20480
    v_mfma_f32_16x16x32_bf16 v[48:51], a[160:163], a[8:11], v[48:51]
    ds_read_b64_tr_b16 a[132:133], v241 offset:16384
    v_mfma_f32_16x16x32_bf16 v[52:55], a[160:163], a[12:15], v[52:55]
    ds_read_b64_tr_b16 a[134:135], v241 offset:20480
    buffer_load_dwordx4 v123, s[52:55], s70 offen offset:3072 lds
    v_mfma_f32_16x16x32_bf16 v[56:59], a[164:167], a[8:11], v[56:59]
    ds_read_b64_tr_b16 a[136:137], v242 offset:16384
    s_add_u32 m0, s67, 69632
    v_mfma_f32_16x16x32_bf16 v[60:63], a[164:167], a[12:15], v[60:63]
    ds_read_b64_tr_b16 a[138:139], v242 offset:20480
    s_mov_b32 s70, s88
    v_mfma_f32_16x16x32_bf16 v[64:67], a[168:171], a[8:11], v[64:67]
    ds_read_b64_tr_b16 a[140:141], v243 offset:16384
    v_mfma_f32_16x16x32_bf16 v[68:71], a[168:171], a[12:15], v[68:71]
    ds_read_b64_tr_b16 a[142:143], v243 offset:20480
    v_mfma_f32_16x16x32_bf16 v[72:75], a[172:175], a[8:11], v[72:75]
    ds_read_b64_tr_b16 a[144:145], v244 offset:16384
    buffer_load_dwordx4 v124, s[52:55], s70 offen lds
    v_mfma_f32_16x16x32_bf16 v[76:79], a[172:175], a[12:15], v[76:79]
    ds_read_b64_tr_b16 a[146:147], v244 offset:20480
    s_waitcnt lgkmcnt(10)
    v_mfma_f32_16x16x32_bf16 v[80:83], a[176:179], a[8:11], v[80:83]
    ds_read_b64_tr_b16 a[148:149], v245 offset:16384
    v_mfma_f32_16x16x32_bf16 v[84:87], a[176:179], a[12:15], v[84:87]
    ds_read_b64_tr_b16 a[150:151], v245 offset:20480
    v_mfma_f32_16x16x32_bf16 v[88:91], a[180:183], a[8:11], v[88:91]
    ds_read_b64_tr_b16 a[152:153], v250 offset:16384
    v_mfma_f32_16x16x32_bf16 v[92:95], a[180:183], a[12:15], v[92:95]
    ds_read_b64_tr_b16 a[154:155], v250 offset:20480
    buffer_load_dwordx4 v125, s[52:55], s70 offen offset:1024 lds
    s_waitcnt lgkmcnt(4)
    v_mfma_f32_16x16x32_bf16 v[40:43], a[128:131], a[16:19], v[40:43]
    ds_read_b64_tr_b16 a[156:157], v240 offset:24576
    v_mfma_f32_16x16x32_bf16 v[44:47], a[128:131], a[20:23], v[44:47]
    ds_read_b64_tr_b16 a[158:159], v240 offset:28672
    v_mfma_f32_16x16x32_bf16 v[48:51], a[132:135], a[16:19], v[48:51]
    ds_read_b64_tr_b16 a[160:161], v241 offset:24576
    v_mfma_f32_16x16x32_bf16 v[52:55], a[132:135], a[20:23], v[52:55]
    ds_read_b64_tr_b16 a[162:163], v241 offset:28672
    v_mfma_f32_16x16x32_bf16 v[56:59], a[136:139], a[16:19], v[56:59]
    ds_read_b64_tr_b16 a[164:165], v242 offset:24576
    buffer_load_dwordx4 v126, s[52:55], s70 offen offset:2048 lds
    v_mfma_f32_16x16x32_bf16 v[60:63], a[136:139], a[20:23], v[60:63]
    ds_read_b64_tr_b16 a[166:167], v242 offset:28672
    v_mfma_f32_16x16x32_bf16 v[64:67], a[140:143], a[16:19], v[64:67]
    ds_read_b64_tr_b16 a[168:169], v243 offset:24576
    v_mfma_f32_16x16x32_bf16 v[68:71], a[140:143], a[20:23], v[68:71]
    ds_read_b64_tr_b16 a[170:171], v243 offset:28672
    v_mfma_f32_16x16x32_bf16 v[72:75], a[144:147], a[16:19], v[72:75]
    ds_read_b64_tr_b16 a[172:173], v244 offset:24576
    v_mfma_f32_16x16x32_bf16 v[76:79], a[144:147], a[20:23], v[76:79]
    ds_read_b64_tr_b16 a[174:175], v244 offset:28672
    buffer_load_dwordx4 v127, s[52:55], s70 offen offset:3072 lds
    s_waitcnt lgkmcnt(10)
    v_mfma_f32_16x16x32_bf16 v[80:83], a[148:151], a[16:19], v[80:83]
    ds_read_b64_tr_b16 a[176:177], v245 offset:24576
    s_lshl_b32 s3, s4, 7
    v_mfma_f32_16x16x32_bf16 v[84:87], a[148:151], a[20:23], v[84:87]
    ds_read_b64_tr_b16 a[178:179], v245 offset:28672
    s_lshl_b32 s7, s5, 3
    v_mfma_f32_16x16x32_bf16 v[88:91], a[152:155], a[16:19], v[88:91]
    ds_read_b64_tr_b16 a[180:181], v250 offset:24576
    s_add_u32 s3, s3, s7
    v_mfma_f32_16x16x32_bf16 v[92:95], a[152:155], a[20:23], v[92:95]
    ds_read_b64_tr_b16 a[182:183], v250 offset:28672
    s_lshl_b32 s7, s6, 1
    s_waitcnt lgkmcnt(0)
    s_waitcnt vmcnt(18)
    s_barrier
    v_add_u32 v240, 32768, v240
    v_add_u32 v241, 32768, v241
    v_add_u32 v242, 32768, v242
    v_add_u32 v243, 32768, v243
    v_add_u32 v244, 32768, v244
    v_add_u32 v245, 32768, v245
    v_add_u32 v250, 32768, v250
    v_mfma_f32_16x16x32_bf16 v[40:43], a[156:159], a[24:27], v[40:43]
    ds_read_b64_tr_b16 a[128:129], v240 offset:0
    s_add_u32 s84, s3, s7
    v_mfma_f32_16x16x32_bf16 v[44:47], a[156:159], a[28:31], v[44:47]
    ds_read_b64_tr_b16 a[130:131], v240 offset:4096
    v_lshrrev_b32 v4, 5, v1
    v_mfma_f32_16x16x32_bf16 v[48:51], a[160:163], a[24:27], v[48:51]
    ds_read_b64_tr_b16 a[132:133], v241 offset:0
    v_add_u32_e64 v4, s84, v4
    v_mfma_f32_16x16x32_bf16 v[52:55], a[160:163], a[28:31], v[52:55]
    ds_read_b64_tr_b16 a[134:135], v241 offset:4096
    v_lshlrev_b32_e64 v4, 10, v4
    v_mfma_f32_16x16x32_bf16 v[56:59], a[164:167], a[24:27], v[56:59]
    ds_read_b64_tr_b16 a[136:137], v242 offset:0
    v_and_b32_e64 v5, 31, v1
    v_mfma_f32_16x16x32_bf16 v[60:63], a[164:167], a[28:31], v[60:63]
    ds_read_b64_tr_b16 a[138:139], v242 offset:4096
    v_lshlrev_b32_e64 v5, 4, v5
    v_mfma_f32_16x16x32_bf16 v[64:67], a[168:171], a[24:27], v[64:67]
    ds_read_b64_tr_b16 a[140:141], v243 offset:0
    v_add_u32_e64 v4, v4, v5
    v_mfma_f32_16x16x32_bf16 v[68:71], a[168:171], a[28:31], v[68:71]
    ds_read_b64_tr_b16 a[142:143], v243 offset:4096
    global_load_dwordx4 v[208:211], v4, s[16:17]
    v_mfma_f32_16x16x32_bf16 v[72:75], a[172:175], a[24:27], v[72:75]
    ds_read_b64_tr_b16 a[144:145], v244 offset:0
    v_mfma_f32_16x16x32_bf16 v[76:79], a[172:175], a[28:31], v[76:79]
    ds_read_b64_tr_b16 a[146:147], v244 offset:4096
    v_mfma_f32_16x16x32_bf16 v[80:83], a[176:179], a[24:27], v[80:83]
    ds_read_b64_tr_b16 a[148:149], v245 offset:0
    v_mfma_f32_16x16x32_bf16 v[84:87], a[176:179], a[28:31], v[84:87]
    ds_read_b64_tr_b16 a[150:151], v245 offset:4096
    v_mfma_f32_16x16x32_bf16 v[88:91], a[180:183], a[24:27], v[88:91]
    ds_read_b64_tr_b16 a[152:153], v250 offset:0
    global_load_dwordx4 v[212:215], v4, s[16:17] offset:512
    v_mfma_f32_16x16x32_bf16 v[92:95], a[180:183], a[28:31], v[92:95]
    ds_read_b64_tr_b16 a[154:155], v250 offset:4096
    s_waitcnt lgkmcnt(4)
    v_mfma_f32_16x16x32_bf16 v[40:43], a[128:131], a[32:35], v[40:43]
    ds_read_b64_tr_b16 a[156:157], v240 offset:8192
    v_mfma_f32_16x16x32_bf16 v[44:47], a[128:131], a[36:39], v[44:47]
    ds_read_b64_tr_b16 a[158:159], v240 offset:12288
    v_mfma_f32_16x16x32_bf16 v[48:51], a[132:135], a[32:35], v[48:51]
    ds_read_b64_tr_b16 a[160:161], v241 offset:8192
    v_mfma_f32_16x16x32_bf16 v[52:55], a[132:135], a[36:39], v[52:55]
    ds_read_b64_tr_b16 a[162:163], v241 offset:12288
    global_load_dwordx4 v[216:219], v5, s[44:45]
    v_mfma_f32_16x16x32_bf16 v[56:59], a[136:139], a[32:35], v[56:59]
    ds_read_b64_tr_b16 a[164:165], v242 offset:8192
    v_mfma_f32_16x16x32_bf16 v[60:63], a[136:139], a[36:39], v[60:63]
    ds_read_b64_tr_b16 a[166:167], v242 offset:12288
    v_mfma_f32_16x16x32_bf16 v[64:67], a[140:143], a[32:35], v[64:67]
    ds_read_b64_tr_b16 a[168:169], v243 offset:8192
    v_mfma_f32_16x16x32_bf16 v[68:71], a[140:143], a[36:39], v[68:71]
    ds_read_b64_tr_b16 a[170:171], v243 offset:12288
    v_mfma_f32_16x16x32_bf16 v[72:75], a[144:147], a[32:35], v[72:75]
    ds_read_b64_tr_b16 a[172:173], v244 offset:8192
    global_load_dwordx4 v[220:223], v5, s[44:45] offset:512
    v_mfma_f32_16x16x32_bf16 v[76:79], a[144:147], a[36:39], v[76:79]
    ds_read_b64_tr_b16 a[174:175], v244 offset:12288
    s_add_u32 m0, s68, 32768
    s_waitcnt lgkmcnt(10)
    v_mfma_f32_16x16x32_bf16 v[80:83], a[148:151], a[32:35], v[80:83]
    ds_read_b64_tr_b16 a[176:177], v245 offset:8192
    s_add_u32 s70, s34, 32768
    v_mfma_f32_16x16x32_bf16 v[84:87], a[148:151], a[36:39], v[84:87]
    ds_read_b64_tr_b16 a[178:179], v245 offset:12288
    v_mfma_f32_16x16x32_bf16 v[88:91], a[152:155], a[32:35], v[88:91]
    ds_read_b64_tr_b16 a[180:181], v250 offset:8192
    v_mfma_f32_16x16x32_bf16 v[92:95], a[152:155], a[36:39], v[92:95]
    ds_read_b64_tr_b16 a[182:183], v250 offset:12288
    buffer_load_dwordx4 v246, s[12:15], s34 offen lds
    s_waitcnt lgkmcnt(4)
    v_mfma_f32_16x16x32_bf16 v[40:43], a[156:159], a[40:43], v[40:43]
    ds_read_b64_tr_b16 a[128:129], v240 offset:16384
    v_mfma_f32_16x16x32_bf16 v[44:47], a[156:159], a[44:47], v[44:47]
    ds_read_b64_tr_b16 a[130:131], v240 offset:20480
    v_mfma_f32_16x16x32_bf16 v[48:51], a[160:163], a[40:43], v[48:51]
    ds_read_b64_tr_b16 a[132:133], v241 offset:16384
    v_mfma_f32_16x16x32_bf16 v[52:55], a[160:163], a[44:47], v[52:55]
    ds_read_b64_tr_b16 a[134:135], v241 offset:20480
    v_mfma_f32_16x16x32_bf16 v[56:59], a[164:167], a[40:43], v[56:59]
    ds_read_b64_tr_b16 a[136:137], v242 offset:16384
    buffer_load_dwordx4 v247, s[12:15], s34 offen offset:1024 lds
    v_mfma_f32_16x16x32_bf16 v[60:63], a[164:167], a[44:47], v[60:63]
    ds_read_b64_tr_b16 a[138:139], v242 offset:20480
    v_mfma_f32_16x16x32_bf16 v[64:67], a[168:171], a[40:43], v[64:67]
    ds_read_b64_tr_b16 a[140:141], v243 offset:16384
    v_mfma_f32_16x16x32_bf16 v[68:71], a[168:171], a[44:47], v[68:71]
    ds_read_b64_tr_b16 a[142:143], v243 offset:20480
    v_mfma_f32_16x16x32_bf16 v[72:75], a[172:175], a[40:43], v[72:75]
    ds_read_b64_tr_b16 a[144:145], v244 offset:16384
    v_mfma_f32_16x16x32_bf16 v[76:79], a[172:175], a[44:47], v[76:79]
    ds_read_b64_tr_b16 a[146:147], v244 offset:20480
    buffer_load_dwordx4 v248, s[12:15], s34 offen offset:2048 lds
    s_waitcnt lgkmcnt(10)
    v_mfma_f32_16x16x32_bf16 v[80:83], a[176:179], a[40:43], v[80:83]
    ds_read_b64_tr_b16 a[148:149], v245 offset:16384
    v_mfma_f32_16x16x32_bf16 v[84:87], a[176:179], a[44:47], v[84:87]
    ds_read_b64_tr_b16 a[150:151], v245 offset:20480
    v_mfma_f32_16x16x32_bf16 v[88:91], a[180:183], a[40:43], v[88:91]
    ds_read_b64_tr_b16 a[152:153], v250 offset:16384
    v_mfma_f32_16x16x32_bf16 v[92:95], a[180:183], a[44:47], v[92:95]
    ds_read_b64_tr_b16 a[154:155], v250 offset:20480
    s_waitcnt lgkmcnt(4)
    v_mfma_f32_16x16x32_bf16 v[40:43], a[128:131], a[48:51], v[40:43]
    ds_read_b64_tr_b16 a[156:157], v240 offset:24576
    buffer_load_dwordx4 v249, s[12:15], s34 offen offset:3072 lds
    v_mfma_f32_16x16x32_bf16 v[44:47], a[128:131], a[52:55], v[44:47]
    ds_read_b64_tr_b16 a[158:159], v240 offset:28672
    s_add_u32 m0, s68, 49152
    v_mfma_f32_16x16x32_bf16 v[48:51], a[132:135], a[48:51], v[48:51]
    ds_read_b64_tr_b16 a[160:161], v241 offset:24576
    s_nop 0
    v_mfma_f32_16x16x32_bf16 v[52:55], a[132:135], a[52:55], v[52:55]
    ds_read_b64_tr_b16 a[162:163], v241 offset:28672
    v_mfma_f32_16x16x32_bf16 v[56:59], a[136:139], a[48:51], v[56:59]
    ds_read_b64_tr_b16 a[164:165], v242 offset:24576
    v_mfma_f32_16x16x32_bf16 v[60:63], a[136:139], a[52:55], v[60:63]
    ds_read_b64_tr_b16 a[166:167], v242 offset:28672
    buffer_load_dwordx4 v246, s[12:15], s70 offen lds
    v_mfma_f32_16x16x32_bf16 v[64:67], a[140:143], a[48:51], v[64:67]
    ds_read_b64_tr_b16 a[168:169], v243 offset:24576
    v_mfma_f32_16x16x32_bf16 v[68:71], a[140:143], a[52:55], v[68:71]
    ds_read_b64_tr_b16 a[170:171], v243 offset:28672
    v_mfma_f32_16x16x32_bf16 v[72:75], a[144:147], a[48:51], v[72:75]
    ds_read_b64_tr_b16 a[172:173], v244 offset:24576
    v_mfma_f32_16x16x32_bf16 v[76:79], a[144:147], a[52:55], v[76:79]
    ds_read_b64_tr_b16 a[174:175], v244 offset:28672
    s_waitcnt lgkmcnt(10)
    v_mfma_f32_16x16x32_bf16 v[80:83], a[148:151], a[48:51], v[80:83]
    ds_read_b64_tr_b16 a[176:177], v245 offset:24576
    buffer_load_dwordx4 v247, s[12:15], s70 offen offset:1024 lds
    v_mfma_f32_16x16x32_bf16 v[84:87], a[148:151], a[52:55], v[84:87]
    ds_read_b64_tr_b16 a[178:179], v245 offset:28672
    v_mfma_f32_16x16x32_bf16 v[88:91], a[152:155], a[48:51], v[88:91]
    ds_read_b64_tr_b16 a[180:181], v250 offset:24576
    v_mfma_f32_16x16x32_bf16 v[92:95], a[152:155], a[52:55], v[92:95]
    ds_read_b64_tr_b16 a[182:183], v250 offset:28672
    s_waitcnt lgkmcnt(0)
    s_waitcnt vmcnt(19)
    s_barrier
    v_subrev_u32 v240, 131072, v240
    v_subrev_u32 v241, 131072, v241
    v_subrev_u32 v242, 131072, v242
    v_subrev_u32 v243, 131072, v243
    v_subrev_u32 v244, 131072, v244
    v_subrev_u32 v245, 131072, v245
    v_subrev_u32 v250, 131072, v250
    v_mfma_f32_16x16x32_bf16 v[40:43], a[156:159], a[56:59], v[40:43]
    ds_read_b64_tr_b16 a[128:129], v240 offset:0
    v_mfma_f32_16x16x32_bf16 v[44:47], a[156:159], a[60:63], v[44:47]
    ds_read_b64_tr_b16 a[130:131], v240 offset:4096
    buffer_load_dwordx4 v248, s[12:15], s70 offen offset:2048 lds
    v_mfma_f32_16x16x32_bf16 v[48:51], a[160:163], a[56:59], v[48:51]
    ds_read_b64_tr_b16 a[132:133], v241 offset:0
    v_mfma_f32_16x16x32_bf16 v[52:55], a[160:163], a[60:63], v[52:55]
    ds_read_b64_tr_b16 a[134:135], v241 offset:4096
    v_mfma_f32_16x16x32_bf16 v[56:59], a[164:167], a[56:59], v[56:59]
    ds_read_b64_tr_b16 a[136:137], v242 offset:0
    v_mfma_f32_16x16x32_bf16 v[60:63], a[164:167], a[60:63], v[60:63]
    ds_read_b64_tr_b16 a[138:139], v242 offset:4096
    v_mfma_f32_16x16x32_bf16 v[64:67], a[168:171], a[56:59], v[64:67]
    ds_read_b64_tr_b16 a[140:141], v243 offset:0
    buffer_load_dwordx4 v249, s[12:15], s70 offen offset:3072 lds
    v_mfma_f32_16x16x32_bf16 v[68:71], a[168:171], a[60:63], v[68:71]
    ds_read_b64_tr_b16 a[142:143], v243 offset:4096
    s_add_u32 s34, s34, s48
    v_mfma_f32_16x16x32_bf16 v[72:75], a[172:175], a[56:59], v[72:75]
    ds_read_b64_tr_b16 a[144:145], v244 offset:0
    s_add_u32 m0, s68, 98304
    v_mfma_f32_16x16x32_bf16 v[76:79], a[172:175], a[60:63], v[76:79]
    ds_read_b64_tr_b16 a[146:147], v244 offset:4096
    s_add_u32 s70, s35, 32768
    v_mfma_f32_16x16x32_bf16 v[80:83], a[176:179], a[56:59], v[80:83]
    ds_read_b64_tr_b16 a[148:149], v245 offset:0
    v_mfma_f32_16x16x32_bf16 v[84:87], a[176:179], a[60:63], v[84:87]
    ds_read_b64_tr_b16 a[150:151], v245 offset:4096
    buffer_load_dwordx4 v246, s[72:75], s35 offen lds
    v_mfma_f32_16x16x32_bf16 v[88:91], a[180:183], a[56:59], v[88:91]
    ds_read_b64_tr_b16 a[152:153], v250 offset:0
    v_mfma_f32_16x16x32_bf16 v[92:95], a[180:183], a[60:63], v[92:95]
    ds_read_b64_tr_b16 a[154:155], v250 offset:4096
    s_waitcnt lgkmcnt(4)
    v_mfma_f32_16x16x32_bf16 v[40:43], a[128:131], a[64:67], v[40:43]
    ds_read_b64_tr_b16 a[156:157], v240 offset:8192
    v_mfma_f32_16x16x32_bf16 v[44:47], a[128:131], a[68:71], v[44:47]
    ds_read_b64_tr_b16 a[158:159], v240 offset:12288
    v_mfma_f32_16x16x32_bf16 v[48:51], a[132:135], a[64:67], v[48:51]
    ds_read_b64_tr_b16 a[160:161], v241 offset:8192
    buffer_load_dwordx4 v247, s[72:75], s35 offen offset:1024 lds
    v_mfma_f32_16x16x32_bf16 v[52:55], a[132:135], a[68:71], v[52:55]
    ds_read_b64_tr_b16 a[162:163], v241 offset:12288
    v_mfma_f32_16x16x32_bf16 v[56:59], a[136:139], a[64:67], v[56:59]
    ds_read_b64_tr_b16 a[164:165], v242 offset:8192
    v_mfma_f32_16x16x32_bf16 v[60:63], a[136:139], a[68:71], v[60:63]
    ds_read_b64_tr_b16 a[166:167], v242 offset:12288
    v_mfma_f32_16x16x32_bf16 v[64:67], a[140:143], a[64:67], v[64:67]
    ds_read_b64_tr_b16 a[168:169], v243 offset:8192
    v_mfma_f32_16x16x32_bf16 v[68:71], a[140:143], a[68:71], v[68:71]
    ds_read_b64_tr_b16 a[170:171], v243 offset:12288
    buffer_load_dwordx4 v248, s[72:75], s35 offen offset:2048 lds
    v_mfma_f32_16x16x32_bf16 v[72:75], a[144:147], a[64:67], v[72:75]
    ds_read_b64_tr_b16 a[172:173], v244 offset:8192
    v_mfma_f32_16x16x32_bf16 v[76:79], a[144:147], a[68:71], v[76:79]
    ds_read_b64_tr_b16 a[174:175], v244 offset:12288
    s_waitcnt lgkmcnt(10)
    v_mfma_f32_16x16x32_bf16 v[80:83], a[148:151], a[64:67], v[80:83]
    ds_read_b64_tr_b16 a[176:177], v245 offset:8192
    v_mfma_f32_16x16x32_bf16 v[84:87], a[148:151], a[68:71], v[84:87]
    ds_read_b64_tr_b16 a[178:179], v245 offset:12288
    v_mfma_f32_16x16x32_bf16 v[88:91], a[152:155], a[64:67], v[88:91]
    ds_read_b64_tr_b16 a[180:181], v250 offset:8192
    buffer_load_dwordx4 v249, s[72:75], s35 offen offset:3072 lds
    v_mfma_f32_16x16x32_bf16 v[92:95], a[152:155], a[68:71], v[92:95]
    ds_read_b64_tr_b16 a[182:183], v250 offset:12288
    s_add_u32 m0, s68, 114688
    s_waitcnt lgkmcnt(4)
    v_mfma_f32_16x16x32_bf16 v[40:43], a[156:159], a[72:75], v[40:43]
    ds_read_b64_tr_b16 a[128:129], v240 offset:16384
    s_nop 0
    v_mfma_f32_16x16x32_bf16 v[44:47], a[156:159], a[76:79], v[44:47]
    ds_read_b64_tr_b16 a[130:131], v240 offset:20480
    v_mfma_f32_16x16x32_bf16 v[48:51], a[160:163], a[72:75], v[48:51]
    ds_read_b64_tr_b16 a[132:133], v241 offset:16384
    v_mfma_f32_16x16x32_bf16 v[52:55], a[160:163], a[76:79], v[52:55]
    ds_read_b64_tr_b16 a[134:135], v241 offset:20480
    buffer_load_dwordx4 v246, s[72:75], s70 offen lds
    v_mfma_f32_16x16x32_bf16 v[56:59], a[164:167], a[72:75], v[56:59]
    ds_read_b64_tr_b16 a[136:137], v242 offset:16384
    v_mfma_f32_16x16x32_bf16 v[60:63], a[164:167], a[76:79], v[60:63]
    ds_read_b64_tr_b16 a[138:139], v242 offset:20480
    v_mfma_f32_16x16x32_bf16 v[64:67], a[168:171], a[72:75], v[64:67]
    ds_read_b64_tr_b16 a[140:141], v243 offset:16384
    v_mfma_f32_16x16x32_bf16 v[68:71], a[168:171], a[76:79], v[68:71]
    ds_read_b64_tr_b16 a[142:143], v243 offset:20480
    v_mfma_f32_16x16x32_bf16 v[72:75], a[172:175], a[72:75], v[72:75]
    ds_read_b64_tr_b16 a[144:145], v244 offset:16384
    buffer_load_dwordx4 v247, s[72:75], s70 offen offset:1024 lds
    v_mfma_f32_16x16x32_bf16 v[76:79], a[172:175], a[76:79], v[76:79]
    ds_read_b64_tr_b16 a[146:147], v244 offset:20480
    s_waitcnt lgkmcnt(10)
    v_mfma_f32_16x16x32_bf16 v[80:83], a[176:179], a[72:75], v[80:83]
    ds_read_b64_tr_b16 a[148:149], v245 offset:16384
    v_mfma_f32_16x16x32_bf16 v[84:87], a[176:179], a[76:79], v[84:87]
    ds_read_b64_tr_b16 a[150:151], v245 offset:20480
    v_mfma_f32_16x16x32_bf16 v[88:91], a[180:183], a[72:75], v[88:91]
    ds_read_b64_tr_b16 a[152:153], v250 offset:16384
    v_mfma_f32_16x16x32_bf16 v[92:95], a[180:183], a[76:79], v[92:95]
    ds_read_b64_tr_b16 a[154:155], v250 offset:20480
    buffer_load_dwordx4 v248, s[72:75], s70 offen offset:2048 lds
    s_waitcnt lgkmcnt(4)
    v_mfma_f32_16x16x32_bf16 v[40:43], a[128:131], a[80:83], v[40:43]
    ds_read_b64_tr_b16 a[156:157], v240 offset:24576
    v_mfma_f32_16x16x32_bf16 v[44:47], a[128:131], a[84:87], v[44:47]
    ds_read_b64_tr_b16 a[158:159], v240 offset:28672
    v_mfma_f32_16x16x32_bf16 v[48:51], a[132:135], a[80:83], v[48:51]
    ds_read_b64_tr_b16 a[160:161], v241 offset:24576
    v_mfma_f32_16x16x32_bf16 v[52:55], a[132:135], a[84:87], v[52:55]
    ds_read_b64_tr_b16 a[162:163], v241 offset:28672
    v_mfma_f32_16x16x32_bf16 v[56:59], a[136:139], a[80:83], v[56:59]
    ds_read_b64_tr_b16 a[164:165], v242 offset:24576
    buffer_load_dwordx4 v249, s[72:75], s70 offen offset:3072 lds
    v_mfma_f32_16x16x32_bf16 v[60:63], a[136:139], a[84:87], v[60:63]
    ds_read_b64_tr_b16 a[166:167], v242 offset:28672
    s_add_u32 s35, s35, s48
    v_mfma_f32_16x16x32_bf16 v[64:67], a[140:143], a[80:83], v[64:67]
    ds_read_b64_tr_b16 a[168:169], v243 offset:24576
    s_add_u32 m0, s68, 131072
    v_mfma_f32_16x16x32_bf16 v[68:71], a[140:143], a[84:87], v[68:71]
    ds_read_b64_tr_b16 a[170:171], v243 offset:28672
    s_add_u32 s70, s34, 32768
    v_mfma_f32_16x16x32_bf16 v[72:75], a[144:147], a[80:83], v[72:75]
    ds_read_b64_tr_b16 a[172:173], v244 offset:24576
    v_mfma_f32_16x16x32_bf16 v[76:79], a[144:147], a[84:87], v[76:79]
    ds_read_b64_tr_b16 a[174:175], v244 offset:28672
    buffer_load_dwordx4 v246, s[12:15], s34 offen lds
    s_waitcnt lgkmcnt(10)
    v_mfma_f32_16x16x32_bf16 v[80:83], a[148:151], a[80:83], v[80:83]
    ds_read_b64_tr_b16 a[176:177], v245 offset:24576
    v_mfma_f32_16x16x32_bf16 v[84:87], a[148:151], a[84:87], v[84:87]
    ds_read_b64_tr_b16 a[178:179], v245 offset:28672
    v_mfma_f32_16x16x32_bf16 v[88:91], a[152:155], a[80:83], v[88:91]
    ds_read_b64_tr_b16 a[180:181], v250 offset:24576
    v_mfma_f32_16x16x32_bf16 v[92:95], a[152:155], a[84:87], v[92:95]
    ds_read_b64_tr_b16 a[182:183], v250 offset:28672
    s_waitcnt lgkmcnt(0)
    s_waitcnt vmcnt(21)
    s_barrier
    v_add_u32 v240, 65536, v240
    v_add_u32 v241, 65536, v241
    v_add_u32 v242, 65536, v242
    v_add_u32 v243, 65536, v243
    v_add_u32 v244, 65536, v244
    v_add_u32 v245, 65536, v245
    v_add_u32 v250, 65536, v250
    v_mfma_f32_16x16x32_bf16 v[40:43], a[156:159], a[88:91], v[40:43]
    ds_read_b64_tr_b16 a[128:129], v240 offset:0
    buffer_load_dwordx4 v247, s[12:15], s34 offen offset:1024 lds
    v_mfma_f32_16x16x32_bf16 v[44:47], a[156:159], a[92:95], v[44:47]
    ds_read_b64_tr_b16 a[130:131], v240 offset:4096
    v_mfma_f32_16x16x32_bf16 v[48:51], a[160:163], a[88:91], v[48:51]
    ds_read_b64_tr_b16 a[132:133], v241 offset:0
    v_mfma_f32_16x16x32_bf16 v[52:55], a[160:163], a[92:95], v[52:55]
    ds_read_b64_tr_b16 a[134:135], v241 offset:4096
    v_mfma_f32_16x16x32_bf16 v[56:59], a[164:167], a[88:91], v[56:59]
    ds_read_b64_tr_b16 a[136:137], v242 offset:0
    v_mfma_f32_16x16x32_bf16 v[60:63], a[164:167], a[92:95], v[60:63]
    ds_read_b64_tr_b16 a[138:139], v242 offset:4096
    buffer_load_dwordx4 v248, s[12:15], s34 offen offset:2048 lds
    v_mfma_f32_16x16x32_bf16 v[64:67], a[168:171], a[88:91], v[64:67]
    ds_read_b64_tr_b16 a[140:141], v243 offset:0
    v_mfma_f32_16x16x32_bf16 v[68:71], a[168:171], a[92:95], v[68:71]
    ds_read_b64_tr_b16 a[142:143], v243 offset:4096
    v_mfma_f32_16x16x32_bf16 v[72:75], a[172:175], a[88:91], v[72:75]
    ds_read_b64_tr_b16 a[144:145], v244 offset:0
    v_mfma_f32_16x16x32_bf16 v[76:79], a[172:175], a[92:95], v[76:79]
    ds_read_b64_tr_b16 a[146:147], v244 offset:4096
    v_mfma_f32_16x16x32_bf16 v[80:83], a[176:179], a[88:91], v[80:83]
    ds_read_b64_tr_b16 a[148:149], v245 offset:0
    buffer_load_dwordx4 v249, s[12:15], s34 offen offset:3072 lds
    v_mfma_f32_16x16x32_bf16 v[84:87], a[176:179], a[92:95], v[84:87]
    ds_read_b64_tr_b16 a[150:151], v245 offset:4096
    s_add_u32 m0, s68, 147456
    v_mfma_f32_16x16x32_bf16 v[88:91], a[180:183], a[88:91], v[88:91]
    ds_read_b64_tr_b16 a[152:153], v250 offset:0
    s_nop 0
    v_mfma_f32_16x16x32_bf16 v[92:95], a[180:183], a[92:95], v[92:95]
    ds_read_b64_tr_b16 a[154:155], v250 offset:4096
    s_waitcnt lgkmcnt(4)
    v_mfma_f32_16x16x32_bf16 v[40:43], a[128:131], a[96:99], v[40:43]
    ds_read_b64_tr_b16 a[156:157], v240 offset:8192
    v_mfma_f32_16x16x32_bf16 v[44:47], a[128:131], a[100:103], v[44:47]
    ds_read_b64_tr_b16 a[158:159], v240 offset:12288
    buffer_load_dwordx4 v246, s[12:15], s70 offen lds
    v_mfma_f32_16x16x32_bf16 v[48:51], a[132:135], a[96:99], v[48:51]
    ds_read_b64_tr_b16 a[160:161], v241 offset:8192
    v_mfma_f32_16x16x32_bf16 v[52:55], a[132:135], a[100:103], v[52:55]
    ds_read_b64_tr_b16 a[162:163], v241 offset:12288
    v_mfma_f32_16x16x32_bf16 v[56:59], a[136:139], a[96:99], v[56:59]
    ds_read_b64_tr_b16 a[164:165], v242 offset:8192
    v_mfma_f32_16x16x32_bf16 v[60:63], a[136:139], a[100:103], v[60:63]
    ds_read_b64_tr_b16 a[166:167], v242 offset:12288
    v_mfma_f32_16x16x32_bf16 v[64:67], a[140:143], a[96:99], v[64:67]
    ds_read_b64_tr_b16 a[168:169], v243 offset:8192
    buffer_load_dwordx4 v247, s[12:15], s70 offen offset:1024 lds
    v_mfma_f32_16x16x32_bf16 v[68:71], a[140:143], a[100:103], v[68:71]
    ds_read_b64_tr_b16 a[170:171], v243 offset:12288
    v_mfma_f32_16x16x32_bf16 v[72:75], a[144:147], a[96:99], v[72:75]
    ds_read_b64_tr_b16 a[172:173], v244 offset:8192
    v_mfma_f32_16x16x32_bf16 v[76:79], a[144:147], a[100:103], v[76:79]
    ds_read_b64_tr_b16 a[174:175], v244 offset:12288
    s_waitcnt lgkmcnt(10)
    v_mfma_f32_16x16x32_bf16 v[80:83], a[148:151], a[96:99], v[80:83]
    ds_read_b64_tr_b16 a[176:177], v245 offset:8192
    v_mfma_f32_16x16x32_bf16 v[84:87], a[148:151], a[100:103], v[84:87]
    ds_read_b64_tr_b16 a[178:179], v245 offset:12288
    buffer_load_dwordx4 v248, s[12:15], s70 offen offset:2048 lds
    v_mfma_f32_16x16x32_bf16 v[88:91], a[152:155], a[96:99], v[88:91]
    ds_read_b64_tr_b16 a[180:181], v250 offset:8192
    v_mfma_f32_16x16x32_bf16 v[92:95], a[152:155], a[100:103], v[92:95]
    ds_read_b64_tr_b16 a[182:183], v250 offset:12288
    s_waitcnt lgkmcnt(4)
    v_mfma_f32_16x16x32_bf16 v[40:43], a[156:159], a[104:107], v[40:43]
    ds_read_b64_tr_b16 a[128:129], v240 offset:16384
    v_mfma_f32_16x16x32_bf16 v[44:47], a[156:159], a[108:111], v[44:47]
    ds_read_b64_tr_b16 a[130:131], v240 offset:20480
    v_mfma_f32_16x16x32_bf16 v[48:51], a[160:163], a[104:107], v[48:51]
    ds_read_b64_tr_b16 a[132:133], v241 offset:16384
    buffer_load_dwordx4 v249, s[12:15], s70 offen offset:3072 lds
    v_mfma_f32_16x16x32_bf16 v[52:55], a[160:163], a[108:111], v[52:55]
    ds_read_b64_tr_b16 a[134:135], v241 offset:20480
    s_add_u32 s34, s34, s48
    v_mfma_f32_16x16x32_bf16 v[56:59], a[164:167], a[104:107], v[56:59]
    ds_read_b64_tr_b16 a[136:137], v242 offset:16384
    s_sub_u32 s3, s4, 1
    v_mfma_f32_16x16x32_bf16 v[60:63], a[164:167], a[108:111], v[60:63]
    ds_read_b64_tr_b16 a[138:139], v242 offset:20480
    v_sub_u32_e64 v4, s3, v3
    v_mfma_f32_16x16x32_bf16 v[64:67], a[168:171], a[104:107], v[64:67]
    ds_read_b64_tr_b16 a[140:141], v243 offset:16384
    v_lshlrev_b32 v4, 9, v4
    v_mfma_f32_16x16x32_bf16 v[68:71], a[168:171], a[108:111], v[68:71]
    ds_read_b64_tr_b16 a[142:143], v243 offset:20480
    v_lshl_add_u32 v4, v2, 5, v4
    v_mfma_f32_16x16x32_bf16 v[72:75], a[172:175], a[104:107], v[72:75]
    ds_read_b64_tr_b16 a[144:145], v244 offset:16384
    v_and_b32 v7, 0x7fffffff, v4
    v_mfma_f32_16x16x32_bf16 v[76:79], a[172:175], a[108:111], v[76:79]
    ds_read_b64_tr_b16 a[146:147], v244 offset:20480
    buffer_load_dwordx4 v[128:131], v7, s[76:79], 0 offen sc1
    s_waitcnt lgkmcnt(10)
    v_mfma_f32_16x16x32_bf16 v[80:83], a[176:179], a[104:107], v[80:83]
    ds_read_b64_tr_b16 a[148:149], v245 offset:16384
    v_mfma_f32_16x16x32_bf16 v[84:87], a[176:179], a[108:111], v[84:87]
    ds_read_b64_tr_b16 a[150:151], v245 offset:20480
    v_mfma_f32_16x16x32_bf16 v[88:91], a[180:183], a[104:107], v[88:91]
    ds_read_b64_tr_b16 a[152:153], v250 offset:16384
    v_mfma_f32_16x16x32_bf16 v[92:95], a[180:183], a[108:111], v[92:95]
    ds_read_b64_tr_b16 a[154:155], v250 offset:20480
    s_waitcnt lgkmcnt(4)
    v_mfma_f32_16x16x32_bf16 v[40:43], a[128:131], a[112:115], v[40:43]
    ds_read_b64_tr_b16 a[156:157], v240 offset:24576
    buffer_load_dwordx4 v[132:135], v7, s[76:79], 0 offen offset:16 sc1
    v_mfma_f32_16x16x32_bf16 v[44:47], a[128:131], a[116:119], v[44:47]
    ds_read_b64_tr_b16 a[158:159], v240 offset:28672
    v_subrev_u32 v4, 2048, v4
    v_mfma_f32_16x16x32_bf16 v[48:51], a[132:135], a[112:115], v[48:51]
    ds_read_b64_tr_b16 a[160:161], v241 offset:24576
    v_and_b32 v7, 0x7fffffff, v4
    v_mfma_f32_16x16x32_bf16 v[52:55], a[132:135], a[116:119], v[52:55]
    ds_read_b64_tr_b16 a[162:163], v241 offset:28672
    v_mfma_f32_16x16x32_bf16 v[56:59], a[136:139], a[112:115], v[56:59]
    ds_read_b64_tr_b16 a[164:165], v242 offset:24576
    v_mfma_f32_16x16x32_bf16 v[60:63], a[136:139], a[116:119], v[60:63]
    ds_read_b64_tr_b16 a[166:167], v242 offset:28672
    buffer_load_dwordx4 v[136:139], v7, s[76:79], 0 offen sc1
    v_mfma_f32_16x16x32_bf16 v[64:67], a[140:143], a[112:115], v[64:67]
    ds_read_b64_tr_b16 a[168:169], v243 offset:24576
    v_mfma_f32_16x16x32_bf16 v[68:71], a[140:143], a[116:119], v[68:71]
    ds_read_b64_tr_b16 a[170:171], v243 offset:28672
    v_mfma_f32_16x16x32_bf16 v[72:75], a[144:147], a[112:115], v[72:75]
    ds_read_b64_tr_b16 a[172:173], v244 offset:24576
    v_mfma_f32_16x16x32_bf16 v[76:79], a[144:147], a[116:119], v[76:79]
    ds_read_b64_tr_b16 a[174:175], v244 offset:28672
    s_waitcnt lgkmcnt(10)
    v_mfma_f32_16x16x32_bf16 v[80:83], a[148:151], a[112:115], v[80:83]
    ds_read_b64_tr_b16 a[176:177], v245 offset:24576
    buffer_load_dwordx4 v[140:143], v7, s[76:79], 0 offen offset:16 sc1
    v_mfma_f32_16x16x32_bf16 v[84:87], a[148:151], a[116:119], v[84:87]
    ds_read_b64_tr_b16 a[178:179], v245 offset:28672
    v_subrev_u32 v4, 2048, v4
    v_mfma_f32_16x16x32_bf16 v[88:91], a[152:155], a[112:115], v[88:91]
    ds_read_b64_tr_b16 a[180:181], v250 offset:24576
    v_and_b32 v7, 0x7fffffff, v4
    v_mfma_f32_16x16x32_bf16 v[92:95], a[152:155], a[116:119], v[92:95]
    ds_read_b64_tr_b16 a[182:183], v250 offset:28672
    s_waitcnt lgkmcnt(0)
    s_barrier
    v_mfma_f32_16x16x32_bf16 v[40:43], a[156:159], a[120:123], v[40:43]
    v_mfma_f32_16x16x32_bf16 v[44:47], a[156:159], a[124:127], v[44:47]
    buffer_load_dwordx4 v[144:147], v7, s[76:79], 0 offen sc1
    v_mfma_f32_16x16x32_bf16 v[48:51], a[160:163], a[120:123], v[48:51]
    v_mfma_f32_16x16x32_bf16 v[52:55], a[160:163], a[124:127], v[52:55]
    v_mfma_f32_16x16x32_bf16 v[56:59], a[164:167], a[120:123], v[56:59]
    v_mfma_f32_16x16x32_bf16 v[60:63], a[164:167], a[124:127], v[60:63]
    v_mfma_f32_16x16x32_bf16 v[64:67], a[168:171], a[120:123], v[64:67]
    buffer_load_dwordx4 v[148:151], v7, s[76:79], 0 offen offset:16 sc1
    v_subrev_u32 v4, 2048, v4
    v_mfma_f32_16x16x32_bf16 v[68:71], a[168:171], a[124:127], v[68:71]
    v_and_b32 v7, 0x7fffffff, v4
    v_mfma_f32_16x16x32_bf16 v[72:75], a[172:175], a[120:123], v[72:75]
    v_mfma_f32_16x16x32_bf16 v[76:79], a[172:175], a[124:127], v[76:79]
    v_mfma_f32_16x16x32_bf16 v[80:83], a[176:179], a[120:123], v[80:83]
    v_mfma_f32_16x16x32_bf16 v[84:87], a[176:179], a[124:127], v[84:87]
    buffer_load_dwordx4 v[96:99], v7, s[76:79], 0 offen sc1
    v_mfma_f32_16x16x32_bf16 v[88:91], a[180:183], a[120:123], v[88:91]
    v_mfma_f32_16x16x32_bf16 v[92:95], a[180:183], a[124:127], v[92:95]
    buffer_load_dwordx4 v[100:103], v7, s[76:79], 0 offen offset:16 sc1
    s_lshl_b32 s3, s4, 1
    s_lshr_b32 s7, s6, 1
    s_add_u32 s3, s3, s7
    s_mul_i32 s91, s3, 360448
    s_and_b32 s7, s6, 1
    s_lshl_b32 s7, s7, 11
    s_add_u32 s91, s91, s7
    s_lshr_b32 s3, s5, 1
    s_mul_i32 s3, s3, 7
    s_add_u32 s3, s3, 32
    s_and_b32 s7, s5, 1
    s_lshl_b32 s92, s7, 2
    s_add_u32 s92, s92, s3
    s_lshl_b32 s92, s92, 12
    s_add_u32 s92, s92, s91
    s_add_u32 s93, s3, 3
    s_lshl_b32 s93, s93, 12
    s_add_u32 s93, s93, s91
    s_lshl_b32 s7, s7, 3
    v_lshlrev_b32 v250, 4, v1
    v_add_u32 v251, s7, v250
    v_max_f32 v40, 0, v40
    v_max_f32 v41, 0, v41
    v_max_f32 v42, 0, v42
    v_max_f32 v43, 0, v43
    v_pk_mul_f32 v[40:41], v[40:41], v[40:41]
    v_pk_mul_f32 v[42:43], v[42:43], v[42:43]
    v_cvt_pk_bf16_f32 v112, v40, v41
    v_cvt_pk_bf16_f32 v113, v42, v43
    v_max_f32_e64 v48, 0, v48
    v_max_f32_e64 v49, 0, v49
    v_max_f32_e64 v50, 0, v50
    v_max_f32 v51, 0, v51
    v_pk_mul_f32 v[48:49], v[48:49], v[48:49]
    v_pk_mul_f32 v[50:51], v[50:51], v[50:51]
    v_cvt_pk_bf16_f32 v114, v48, v49
    v_cvt_pk_bf16_f32 v115, v50, v51
    buffer_store_dwordx4 v[112:115], v250, s[56:59], s92 offen sc1
    s_waitcnt vmcnt(33)
    v_dot2_f32_bf16 v240, v208, v216, 0
    v_dot2_f32_bf16 v241, v209, v217, 0
    v_dot2_f32_bf16 v240, v210, v218, v240
    v_dot2_f32_bf16 v241, v211, v219, v241
    v_dot2_f32_bf16 v240, v212, v220, v240
    v_dot2_f32_bf16 v241, v213, v221, v241
    v_dot2_f32_bf16 v240, v214, v222, v240
    v_dot2_f32_bf16 v241, v215, v223, v241
    s_nop 2
    v_add_f32_e64 v240, v240, v241
    s_nop 1
    v_add_f32_dpp v240, v240, v240 quad_perm:[1,0,3,2] row_mask:0xf bank_mask:0xf
    s_nop 1
    v_add_f32_dpp v240, v240, v240 quad_perm:[2,3,0,1] row_mask:0xf bank_mask:0xf
    s_nop 1
    v_add_f32_dpp v240, v240, v240 row_half_mirror row_mask:0xf bank_mask:0xf
    s_nop 1
    v_add_f32_dpp v240, v240, v240 row_mirror row_mask:0xf bank_mask:0xf
    v_mov_b32 v241, v240
    s_nop 1
    v_permlane16_swap_b32 v241, v240
    s_nop 0
    v_add_f32 v240, v240, v241
    v_cvt_pk_bf16_f32 v240, v240, v240
    v_lshlrev_b32 v240, 16, v240
    v_mul_f32 v240, s80, v240
    v_sub_f32 v240, 0, v240
    v_exp_f32 v240, v240
    s_nop 0
    v_add_f32 v240, 1.0, v240
    v_rcp_f32 v240, v240
    s_nop 0
    v_cvt_pk_bf16_f32 v240, v240, v240
    v_lshlrev_b32 v242, 16, v240
    v_sub_f32 v243, 1.0, v242
    v_cvt_pk_bf16_f32 v243, v243, v243
    v_lshlrev_b32 v243, 16, v243
    v_lshrrev_b32 v4, 5, v1
    v_add_u32 v4, s84, v4
    v_max_f32 v44, 0, v44
    v_max_f32 v45, 0, v45
    v_max_f32 v46, 0, v46
    v_max_f32_e64 v47, 0, v47
    v_pk_mul_f32 v[44:45], v[44:45], v[44:45]
    v_pk_mul_f32 v[46:47], v[46:47], v[46:47]
    v_cvt_pk_bf16_f32 v116, v44, v45
    v_cvt_pk_bf16_f32 v117, v46, v47
    v_max_f32 v52, 0, v52
    v_max_f32 v53, 0, v53
    v_max_f32 v54, 0, v54
    v_max_f32 v55, 0, v55
    v_pk_mul_f32 v[52:53], v[52:53], v[52:53]
    v_pk_mul_f32 v[54:55], v[54:55], v[54:55]
    v_cvt_pk_bf16_f32 v118, v52, v53
    v_cvt_pk_bf16_f32 v119, v54, v55
    buffer_store_dwordx4 v[116:119], v250, s[56:59], s92 offen offset:1024 sc1
    v_lshlrev_b32_e64 v4, 3, v4
    v_add_u32 v4, 11665408, v4
    v_and_b32 v5, 31, v1
    v_cmp_eq_u32 vcc, 0, v5
    v_mov_b32 v5, 0x7fffff00
    s_nop 0
    v_cndmask_b32 v4, v5, v4, vcc
    buffer_store_dwordx2 v[242:243], v4, s[56:59], 0 offen sc1
    v_add_u32 v4, 0, v3
    v_cmp_gt_u32 vcc, s4, v4
    s_nop 0
    v_cndmask_b32 v104, 0, -1, vcc
    v_add_u32 v4, 4, v3
    v_cmp_gt_u32 vcc, s4, v4
    s_nop 0
    v_cndmask_b32 v105, 0, -1, vcc
    v_add_u32 v4, 8, v3
    v_cmp_gt_u32_e64 vcc, s4, v4
    s_nop 0
    v_cndmask_b32 v106, 0, -1, vcc
    v_add_u32 v4, 12, v3
    v_cmp_gt_u32_e64 vcc, s4, v4
    s_nop 0
    v_cndmask_b32 v107, 0, -1, vcc
    s_waitcnt vmcnt(27)
    s_cmp_gt_i32 s90, 0
    s_cbranch_scc0 L_tr_2
    ds_read_b128 a[192:195], v234 offset:32768
    ds_read_b128 a[196:199], v234 offset:34816
    ds_read_b128 a[200:203], v234 offset:49152
    ds_read_b128 a[204:207], v234 offset:51200
    ds_read_b128 a[208:211], v239 offset:32768
    ds_read_b128 a[212:215], v239 offset:34816
    ds_read_b128 a[216:219], v239 offset:49152
    ds_read_b128 a[220:223], v239 offset:51200
    s_branch L_tj_3
L_tr_2:
    ds_read_b64_tr_b16 a[192:193], v235 offset:32768
    ds_read_b64_tr_b16 a[194:195], v235 offset:34816
    ds_read_b64_tr_b16 a[196:197], v236 offset:32768
    ds_read_b64_tr_b16 a[198:199], v236 offset:34816
    ds_read_b64_tr_b16 a[200:201], v237 offset:32768
    ds_read_b64_tr_b16 a[202:203], v237 offset:34816
    ds_read_b64_tr_b16 a[204:205], v238 offset:32768
    ds_read_b64_tr_b16 a[206:207], v238 offset:34816
    ds_read_b64_tr_b16 a[208:209], v235 offset:49152
    ds_read_b64_tr_b16 a[210:211], v235 offset:51200
    ds_read_b64_tr_b16 a[212:213], v236 offset:49152
    ds_read_b64_tr_b16 a[214:215], v236 offset:51200
    ds_read_b64_tr_b16 a[216:217], v237 offset:49152
    ds_read_b64_tr_b16 a[218:219], v237 offset:51200
    ds_read_b64_tr_b16 a[220:221], v238 offset:49152
    ds_read_b64_tr_b16 a[222:223], v238 offset:51200
L_tj_3:
    s_waitcnt vmcnt(19)
    s_cmp_gt_i32 s90, 2
    s_cbranch_scc0 L_tr_4
    ds_read_b128 a[224:227], v224 offset:0
    ds_read_b128 a[228:231], v224 offset:2048
    ds_read_b128 a[232:235], v224 offset:16384
    ds_read_b128 a[236:239], v224 offset:18432
    ds_read_b128 a[240:243], v230 offset:0
    ds_read_b128 a[244:247], v230 offset:2048
    ds_read_b128 a[248:251], v230 offset:16384
    ds_read_b128 a[252:255], v230 offset:18432
    s_branch L_tj_5
L_tr_4:
    ds_read_b64_tr_b16 a[224:225], v225 offset:0
    ds_read_b64_tr_b16 a[226:227], v225 offset:2048
    ds_read_b64_tr_b16 a[228:229], v226 offset:0
    ds_read_b64_tr_b16 a[230:231], v226 offset:2048
    ds_read_b64_tr_b16 a[232:233], v227 offset:0
    ds_read_b64_tr_b16 a[234:235], v227 offset:2048
    ds_read_b64_tr_b16 a[236:237], v228 offset:0
    ds_read_b64_tr_b16 a[238:239], v228 offset:2048
    ds_read_b64_tr_b16 a[240:241], v225 offset:16384
    ds_read_b64_tr_b16 a[242:243], v225 offset:18432
    ds_read_b64_tr_b16 a[244:245], v226 offset:16384
    ds_read_b64_tr_b16 a[246:247], v226 offset:18432
    ds_read_b64_tr_b16 a[248:249], v227 offset:16384
    ds_read_b64_tr_b16 a[250:251], v227 offset:18432
    ds_read_b64_tr_b16 a[252:253], v228 offset:16384
    ds_read_b64_tr_b16 a[254:255], v228 offset:18432
L_tj_5:
    s_waitcnt vmcnt(11)
    s_cmp_gt_i32 s90, 4
    s_cbranch_scc0 L_tr_6
    ds_read_b128 a[0:3], v224 offset:32768
    ds_read_b128 a[4:7], v224 offset:34816
    ds_read_b128 a[8:11], v224 offset:49152
    ds_read_b128 a[12:15], v224 offset:51200
    ds_read_b128 a[16:19], v230 offset:32768
    ds_read_b128 a[20:23], v230 offset:34816
    ds_read_b128 a[24:27], v230 offset:49152
    ds_read_b128 a[28:31], v230 offset:51200
    s_branch L_tj_7
L_tr_6:
    ds_read_b64_tr_b16 a[0:1], v225 offset:32768
    ds_read_b64_tr_b16 a[2:3], v225 offset:34816
    ds_read_b64_tr_b16 a[4:5], v226 offset:32768
    ds_read_b64_tr_b16 a[6:7], v226 offset:34816
    ds_read_b64_tr_b16 a[8:9], v227 offset:32768
    ds_read_b64_tr_b16 a[10:11], v227 offset:34816
    ds_read_b64_tr_b16 a[12:13], v228 offset:32768
    ds_read_b64_tr_b16 a[14:15], v228 offset:34816
    ds_read_b64_tr_b16 a[16:17], v225 offset:49152
    ds_read_b64_tr_b16 a[18:19], v225 offset:51200
    ds_read_b64_tr_b16 a[20:21], v226 offset:49152
    ds_read_b64_tr_b16 a[22:23], v226 offset:51200
    ds_read_b64_tr_b16 a[24:25], v227 offset:49152
    ds_read_b64_tr_b16 a[26:27], v227 offset:51200
    ds_read_b64_tr_b16 a[28:29], v228 offset:49152
    ds_read_b64_tr_b16 a[30:31], v228 offset:51200
L_tj_7:
    v_max_f32 v56, 0, v56
    v_max_f32 v57, 0, v57
    v_max_f32 v58, 0, v58
    v_max_f32 v59, 0, v59
    v_pk_mul_f32 v[56:57], v[56:57], v[56:57]
    v_pk_mul_f32 v[58:59], v[58:59], v[58:59]
    v_cvt_pk_bf16_f32 v112, v56, v57
    v_cvt_pk_bf16_f32 v113, v58, v59
    v_max_f32 v64, 0, v64
    v_max_f32 v65, 0, v65
    v_max_f32 v66, 0, v66
    v_max_f32 v67, 0, v67
    v_pk_mul_f32 v[64:65], v[64:65], v[64:65]
    v_pk_mul_f32 v[66:67], v[66:67], v[66:67]
    v_cvt_pk_bf16_f32 v114, v64, v65
    v_cvt_pk_bf16_f32 v115, v66, v67
    s_add_u32 s92, s92, 4096
    buffer_store_dwordx4 v[112:115], v250, s[56:59], s92 offen sc1
    s_mov_b32 s96, 0x20000
    s_waitcnt vmcnt(4)
L_echk_8:
    v_mov_b32 v4, 0
    v_xor_b32 v5, s97, v130
    v_xor_b32 v7, s97, v134
    v_or_b32_e64 v5, v5, v7
    v_and_or_b32 v4, v5, v104, v4
    v_xor_b32 v5, s97, v138
    v_xor_b32 v7, s97, v142
    v_or_b32 v5, v5, v7
    v_and_or_b32 v4, v5, v105, v4
    v_xor_b32 v5, s97, v146
    v_xor_b32 v7, s97, v150
    v_or_b32 v5, v5, v7
    v_and_or_b32 v4, v5, v106, v4
    v_xor_b32 v5, s97, v98
    v_xor_b32 v7, s97, v102
    v_or_b32_e64 v5, v5, v7
    v_and_or_b32 v4, v5, v107, v4
    v_cmp_ne_u32 vcc, 0, v4
    s_nop 3
    s_cmp_eq_u64 vcc, 0
    s_cbranch_scc1 L_eok_9
    s_sub_u32 s96, s96, 1
    s_cmp_eq_u32 s96, 0
    s_cbranch_scc1 L_eok_9
    s_sleep 4
    s_sub_u32 s3, s4, 1
    v_sub_u32 v4, s3, v3
    v_lshlrev_b32_e64 v4, 9, v4
    v_lshl_add_u32 v4, v2, 5, v4
    v_and_b32 v7, 0x7fffffff, v4
    buffer_load_dwordx4 v[128:131], v7, s[76:79], 0 offen sc1
    buffer_load_dwordx4 v[132:135], v7, s[76:79], 0 offen offset:16 sc1
    v_subrev_u32 v4, 2048, v4
    v_and_b32 v7, 0x7fffffff, v4
    buffer_load_dwordx4 v[136:139], v7, s[76:79], 0 offen sc1
    buffer_load_dwordx4 v[140:143], v7, s[76:79], 0 offen offset:16 sc1
    v_subrev_u32 v4, 2048, v4
    v_and_b32 v7, 0x7fffffff, v4
    buffer_load_dwordx4 v[144:147], v7, s[76:79], 0 offen sc1
    buffer_load_dwordx4 v[148:151], v7, s[76:79], 0 offen offset:16 sc1
    v_subrev_u32 v4, 2048, v4
    v_and_b32 v7, 0x7fffffff, v4
    buffer_load_dwordx4 v[96:99], v7, s[76:79], 0 offen sc1
    buffer_load_dwordx4 v[100:103], v7, s[76:79], 0 offen offset:16 sc1
    s_waitcnt vmcnt(0)
    s_branch L_echk_8
L_eok_9:
    v_max_f32 v60, 0, v60
    v_max_f32 v61, 0, v61
    v_max_f32 v62, 0, v62
    v_max_f32 v63, 0, v63
    v_pk_mul_f32 v[60:61], v[60:61], v[60:61]
    v_pk_mul_f32 v[62:63], v[62:63], v[62:63]
    v_cvt_pk_bf16_f32 v116, v60, v61
    v_cvt_pk_bf16_f32 v117, v62, v63
    v_max_f32 v68, 0, v68
    v_max_f32 v69, 0, v69
    v_max_f32 v70, 0, v70
    v_max_f32 v71, 0, v71
    v_pk_mul_f32 v[68:69], v[68:69], v[68:69]
    v_pk_mul_f32 v[70:71], v[70:71], v[70:71]
    v_cvt_pk_bf16_f32 v118, v68, v69
    v_cvt_pk_bf16_f32 v119, v70, v71
    buffer_store_dwordx4 v[116:119], v250, s[56:59], s92 offen offset:1024 sc1
    v_fmac_f32 v144, v173, v96
    v_fmac_f32 v145, v173, v97
    v_fma_f32 v144, -v174, v97, v144
    v_fmac_f32 v145, v174, v96
    v_fmac_f32 v148, v195, v100
    v_fmac_f32 v149, v195, v101
    v_fma_f32 v148, -v196, v101, v148
    v_fmac_f32 v149, v196, v100
    v_fmac_f32 v136, v173, v144
    v_fmac_f32 v137, v173, v145
    v_fma_f32 v136, -v174, v145, v136
    v_fmac_f32 v137, v174, v144
    v_fmac_f32 v140, v195, v148
    v_fmac_f32 v141, v195, v149
    v_fma_f32 v140, -v196, v149, v140
    v_fmac_f32 v141, v196, v148
    v_fmac_f32 v128, v173, v136
    v_fmac_f32 v129, v173, v137
    v_fma_f32 v128, -v174, v137, v128
    v_fmac_f32 v129, v174, v136
    v_fmac_f32 v132, v195, v140
    v_fmac_f32 v133, v195, v141
    v_fma_f32 v132, -v196, v141, v132
    v_fmac_f32 v133, v196, v140
    v_mul_f32 v120, v171, v128
    v_mul_f32 v121, v171, v129
    v_fma_f32 v120, -v172, v129, v120
    v_fmac_f32 v121, v172, v128
    v_mul_f32 v122, v193, v132
    v_mul_f32_e64 v123, v193, v133
    v_fma_f32 v122, -v194, v133, v122
    v_fmac_f32 v123, v194, v132
    v_mov_b32 v124, v120
    v_mov_b32 v125, v121
    v_mov_b32 v126, v122
    v_mov_b32 v127, v123
    s_nop 0
    v_permlane16_swap_b32 v124, v120
    v_permlane16_swap_b32 v125, v121
    v_permlane16_swap_b32 v126, v122
    v_max_f32 v72, 0, v72
    v_max_f32 v73, 0, v73
    v_max_f32 v74, 0, v74
    v_max_f32_e64 v75, 0, v75
    v_pk_mul_f32 v[72:73], v[72:73], v[72:73]
    v_pk_mul_f32 v[74:75], v[74:75], v[74:75]
    v_cvt_pk_bf16_f32 v112, v72, v73
    v_cvt_pk_bf16_f32 v113, v74, v75
    v_max_f32 v80, 0, v80
    v_max_f32 v81, 0, v81
    v_max_f32 v82, 0, v82
    v_max_f32 v83, 0, v83
    v_pk_mul_f32 v[80:81], v[80:81], v[80:81]
    v_pk_mul_f32 v[82:83], v[82:83], v[82:83]
    v_cvt_pk_bf16_f32 v114, v80, v81
    v_cvt_pk_bf16_f32 v115, v82, v83
    s_add_u32 s92, s92, 4096
    buffer_store_dwordx4 v[112:115], v250, s[56:59], s92 offen sc1
    v_permlane16_swap_b32 v127, v123
    s_nop 0
    v_add_f32 v120, v120, v124
    v_add_f32 v121, v121, v125
    v_add_f32 v122, v122, v126
    v_add_f32 v123, v123, v127
    v_mov_b32 v124, v120
    v_mov_b32 v125, v121
    v_mov_b32 v126, v122
    v_mov_b32 v127, v123
    s_nop 0
    v_permlane32_swap_b32 v124, v120
    v_permlane32_swap_b32 v125, v121
    v_permlane32_swap_b32 v126, v122
    v_permlane32_swap_b32 v127, v123
    s_nop 0
    v_add_f32 v120, v120, v124
    v_add_f32 v121, v121, v125
    v_add_f32 v122, v122, v126
    v_add_f32 v123, v123, v127
    v_fmac_f32 v204, v169, v120
    v_fmac_f32 v205, v169, v121
    v_fma_f32 v204, -v170, v121, v204
    v_fmac_f32 v205, v170, v120
    v_fmac_f32 v206, v191, v122
    v_fmac_f32 v207, v191, v123
    v_fma_f32 v206, -v192, v123, v206
    v_fmac_f32 v207, v192, v122
    v_fmac_f32 v200, v165, v204
    v_fmac_f32 v201, v165, v205
    v_fma_f32 v200, -v166, v205, v200
    v_fmac_f32 v201, v166, v204
    v_fmac_f32 v202, v187, v206
    v_fmac_f32 v203, v187, v207
    v_fma_f32 v202, -v188, v207, v202
    v_fmac_f32 v203, v188, v206
    v_fmac_f32 v8, v156, v200
    v_fmac_f32 v16, v156, v201
    v_fmac_f32 v8, v158, v201
    v_fmac_f32 v16, v157, v200
    v_max_f32 v76, 0, v76
    v_max_f32 v77, 0, v77
    v_max_f32 v78, 0, v78
    v_max_f32 v79, 0, v79
    v_pk_mul_f32 v[76:77], v[76:77], v[76:77]
    v_pk_mul_f32 v[78:79], v[78:79], v[78:79]
    v_cvt_pk_bf16_f32 v116, v76, v77
    v_cvt_pk_bf16_f32 v117, v78, v79
    v_max_f32 v84, 0, v84
    v_max_f32 v85, 0, v85
    v_max_f32 v86, 0, v86
    v_max_f32 v87, 0, v87
    v_pk_mul_f32 v[84:85], v[84:85], v[84:85]
    v_pk_mul_f32 v[86:87], v[86:87], v[86:87]
    v_cvt_pk_bf16_f32 v118, v84, v85
    v_cvt_pk_bf16_f32 v119, v86, v87
    buffer_store_dwordx4 v[116:119], v250, s[56:59], s92 offen offset:1024 sc1
    v_fmac_f32 v12, v178, v202
    v_fmac_f32 v20, v178, v203
    v_fmac_f32 v12, v180, v203
    v_fmac_f32 v20, v179, v202
    v_fmac_f32 v9, v156, v8
    v_fmac_f32 v17, v156, v16
    v_fmac_f32 v9, v158, v16
    v_fmac_f32 v17, v157, v8
    v_fmac_f32 v13, v178, v12
    v_fmac_f32 v21, v178, v20
    v_fmac_f32 v13, v180, v20
    v_fmac_f32 v21, v179, v12
    v_fmac_f32 v10, v156, v9
    v_fmac_f32 v18, v156, v17
    v_fmac_f32 v10, v158, v17
    v_fmac_f32 v18, v157, v9
    v_fmac_f32 v14, v178, v13
    v_fmac_f32 v22, v178, v21
    v_fmac_f32 v14, v180, v21
    v_fmac_f32 v22, v179, v13
    v_fmac_f32 v11, v156, v10
    v_fmac_f32 v19, v156, v18
    v_fmac_f32 v11, v158, v18
    v_fmac_f32 v19, v157, v10
    v_fmac_f32 v15, v178, v14
    v_fmac_f32 v23, v178, v22
    v_fmac_f32 v15, v180, v22
    v_fmac_f32 v23, v179, v14
    v_fmac_f32 v24, v156, v11
    v_fmac_f32 v32, v156, v19
    v_fmac_f32 v24, v158, v19
    v_fmac_f32 v32, v157, v11
    v_fmac_f32 v28, v178, v15
    v_fmac_f32 v36, v178, v23
    v_fmac_f32 v28, v180, v23
    v_fmac_f32 v36, v179, v15
    v_fmac_f32 v25, v156, v24
    v_fmac_f32 v33, v156, v32
    v_fmac_f32 v25, v158, v32
    v_fmac_f32 v33, v157, v24
    v_max_f32 v88, 0, v88
    v_max_f32 v89, 0, v89
    v_max_f32 v90, 0, v90
    v_max_f32 v91, 0, v91
    v_pk_mul_f32 v[88:89], v[88:89], v[88:89]
    v_pk_mul_f32 v[90:91], v[90:91], v[90:91]
    v_cvt_pk_bf16_f32 v112, v88, v89
    v_cvt_pk_bf16_f32 v113, v90, v91
    buffer_store_dwordx2 v[112:113], v251, s[56:59], s93 offen sc1
    v_fmac_f32 v29, v178, v28
    v_fmac_f32 v37, v178, v36
    v_fmac_f32 v29, v180, v36
    v_fmac_f32 v37, v179, v28
    v_fmac_f32 v26, v156, v25
    v_fmac_f32 v34, v156, v33
    v_fmac_f32 v26, v158, v33
    v_fmac_f32 v34, v157, v25
    v_fmac_f32 v30, v178, v29
    v_fmac_f32 v38, v178, v37
    v_fmac_f32 v30, v180, v37
    v_fmac_f32 v38, v179, v29
    v_fmac_f32 v27, v156, v26
    v_fmac_f32 v35, v156, v34
    v_fmac_f32 v27, v158, v34
    v_fmac_f32 v35, v157, v26
    v_fmac_f32 v31, v178, v30
    v_fmac_f32 v39, v178, v38
    v_fmac_f32 v31, v180, v38
    v_fmac_f32 v39, v179, v30
    v_lshrrev_b32 v4, 3, v2
    v_mul_u32_u24 v4, 272, v4
    v_lshl_add_u32 v4, v3, 6, v4
    v_and_b32 v5, 7, v2
    v_lshl_add_u32 v4, v5, 1, v4
    s_mul_i32 s3, s6, 4352
    s_add_u32 s3, s3, 65536
    v_add_u32_e64 v4, s3, v4
    v_mul_u32_u24 v5, 272, v3
    v_lshl_add_u32 v5, v2, 4, v5
    v_add_u32_e64 v5, s3, v5
    s_lshr_b32 s3, s5, 1
    s_lshl_b32 s3, s3, 2
    s_and_b32 s7, s5, 1
    s_add_u32 s3, s3, s7
    s_lshl_b32 s3, s3, 12
    s_add_u32 s82, s3, s91
    s_add_u32 s83, s82, 8192
    v_pk_mul_f32 v[128:129], v[8:9], v[176:177] op_sel_hi:[1,0]
    v_pk_mul_f32 v[132:133], v[16:17], v[176:177] op_sel_hi:[1,0]
    v_pk_fma_f32 v[128:129], v[16:17], v[176:177], v[128:129] op_sel:[0,1,0] op_sel_hi:[1,1,1] neg_lo:[1,0,0] neg_hi:[1,0,0]
    v_pk_fma_f32 v[132:133], v[8:9], v[176:177], v[132:133] op_sel:[0,1,0] op_sel_hi:[1,1,1]
    v_pk_mul_f32 v[130:131], v[10:11], v[176:177] op_sel_hi:[1,0]
    v_pk_mul_f32 v[134:135], v[18:19], v[176:177] op_sel_hi:[1,0]
    v_pk_fma_f32 v[130:131], v[18:19], v[176:177], v[130:131] op_sel:[0,1,0] op_sel_hi:[1,1,1] neg_lo:[1,0,0] neg_hi:[1,0,0]
    v_pk_fma_f32 v[134:135], v[10:11], v[176:177], v[134:135] op_sel:[0,1,0] op_sel_hi:[1,1,1]
    v_pk_mul_f32 v[136:137], v[12:13], v[198:199] op_sel_hi:[1,0]
    v_pk_mul_f32 v[140:141], v[20:21], v[198:199] op_sel_hi:[1,0]
    v_pk_fma_f32 v[136:137], v[20:21], v[198:199], v[136:137] op_sel:[0,1,0] op_sel_hi:[1,1,1] neg_lo:[1,0,0] neg_hi:[1,0,0]
    v_pk_fma_f32 v[140:141], v[12:13], v[198:199], v[140:141] op_sel:[0,1,0] op_sel_hi:[1,1,1]
    v_pk_mul_f32 v[138:139], v[14:15], v[198:199] op_sel_hi:[1,0]
    v_pk_mul_f32 v[142:143], v[22:23], v[198:199] op_sel_hi:[1,0]
    v_max_f32 v92, 0, v92
    v_max_f32_e64 v93, 0, v93
    v_max_f32_e64 v94, 0, v94
    v_max_f32_e64 v95, 0, v95
    v_pk_mul_f32 v[92:93], v[92:93], v[92:93]
    v_pk_mul_f32 v[94:95], v[94:95], v[94:95]
    v_cvt_pk_bf16_f32 v116, v92, v93
    v_cvt_pk_bf16_f32 v117, v94, v95
    buffer_store_dwordx2 v[116:117], v251, s[56:59], s93 offen offset:1024 sc1
    v_pk_fma_f32 v[138:139], v[22:23], v[198:199], v[138:139] op_sel:[0,1,0] op_sel_hi:[1,1,1] neg_lo:[1,0,0] neg_hi:[1,0,0]
    v_pk_fma_f32 v[142:143], v[14:15], v[198:199], v[142:143] op_sel:[0,1,0] op_sel_hi:[1,1,1]
    v_cvt_pk_bf16_f32 v144, v128, v136
    ds_write_b16 v4, v144 offset:0
    ds_write_b16_d16_hi v4, v144 offset:544
    v_cvt_pk_bf16_f32 v145, v129, v137
    ds_write_b16 v4, v145 offset:16
    ds_write_b16_d16_hi v4, v145 offset:560
    v_cvt_pk_bf16_f32 v144, v130, v138
    ds_write_b16 v4, v144 offset:32
    ds_write_b16_d16_hi v4, v144 offset:576
    v_cvt_pk_bf16_f32 v145, v131, v139
    ds_write_b16 v4, v145 offset:48
    ds_write_b16_d16_hi v4, v145 offset:592
    v_cvt_pk_bf16_f32 v146, -v132, -v140
    ds_write_b16 v4, v146 offset:1088
    ds_write_b16_d16_hi v4, v146 offset:1632
    v_cvt_pk_bf16_f32 v147, -v133, -v141
    ds_write_b16 v4, v147 offset:1104
    ds_write_b16_d16_hi v4, v147 offset:1648
    v_cvt_pk_bf16_f32 v146, -v134, -v142
    ds_write_b16 v4, v146 offset:1120
    ds_write_b16_d16_hi v4, v146 offset:1664
    v_cvt_pk_bf16_f32 v147, -v135, -v143
    ds_write_b16 v4, v147 offset:1136
    ds_write_b16_d16_hi v4, v147 offset:1680
    s_waitcnt lgkmcnt(0)
    ds_read_b128 v[148:151], v5 offset:0
    ds_read_b128 v[96:99], v5 offset:1088
    v_pk_mul_f32 v[128:129], v[24:25], v[176:177] op_sel_hi:[1,0]
    v_pk_mul_f32 v[132:133], v[32:33], v[176:177] op_sel_hi:[1,0]
    v_pk_fma_f32 v[128:129], v[32:33], v[176:177], v[128:129] op_sel:[0,1,0] op_sel_hi:[1,1,1] neg_lo:[1,0,0] neg_hi:[1,0,0]
    v_pk_fma_f32 v[132:133], v[24:25], v[176:177], v[132:133] op_sel:[0,1,0] op_sel_hi:[1,1,1]
    v_pk_mul_f32 v[130:131], v[26:27], v[176:177] op_sel_hi:[1,0]
    v_pk_mul_f32 v[134:135], v[34:35], v[176:177] op_sel_hi:[1,0]
    v_pk_fma_f32 v[130:131], v[34:35], v[176:177], v[130:131] op_sel:[0,1,0] op_sel_hi:[1,1,1] neg_lo:[1,0,0] neg_hi:[1,0,0]
    v_pk_fma_f32 v[134:135], v[26:27], v[176:177], v[134:135] op_sel:[0,1,0] op_sel_hi:[1,1,1]
    v_pk_mul_f32 v[136:137], v[28:29], v[198:199] op_sel_hi:[1,0]
    v_pk_mul_f32 v[140:141], v[36:37], v[198:199] op_sel_hi:[1,0]
    v_pk_fma_f32 v[136:137], v[36:37], v[198:199], v[136:137] op_sel:[0,1,0] op_sel_hi:[1,1,1] neg_lo:[1,0,0] neg_hi:[1,0,0]
    v_pk_fma_f32 v[140:141], v[28:29], v[198:199], v[140:141] op_sel:[0,1,0] op_sel_hi:[1,1,1]
    v_pk_mul_f32 v[138:139], v[30:31], v[198:199] op_sel_hi:[1,0]
    v_pk_mul_f32 v[142:143], v[38:39], v[198:199] op_sel_hi:[1,0]
    v_pk_fma_f32 v[138:139], v[38:39], v[198:199], v[138:139] op_sel:[0,1,0] op_sel_hi:[1,1,1] neg_lo:[1,0,0] neg_hi:[1,0,0]
    v_pk_fma_f32 v[142:143], v[30:31], v[198:199], v[142:143] op_sel:[0,1,0] op_sel_hi:[1,1,1]
    v_cvt_pk_bf16_f32 v144, v128, v136
    ds_write_b16 v4, v144 offset:2176
    ds_write_b16_d16_hi v4, v144 offset:2720
    v_cvt_pk_bf16_f32 v145, v129, v137
    ds_write_b16 v4, v145 offset:2192
    ds_write_b16_d16_hi v4, v145 offset:2736
    v_cvt_pk_bf16_f32 v144, v130, v138
    ds_write_b16 v4, v144 offset:2208
    ds_write_b16_d16_hi v4, v144 offset:2752
    v_cvt_pk_bf16_f32 v145, v131, v139
    ds_write_b16 v4, v145 offset:2224
    ds_write_b16_d16_hi v4, v145 offset:2768
    v_cvt_pk_bf16_f32 v146, -v132, -v140
    ds_write_b16 v4, v146 offset:3264
    ds_write_b16_d16_hi v4, v146 offset:3808
    v_cvt_pk_bf16_f32 v147, -v133, -v141
    ds_write_b16 v4, v147 offset:3280
    ds_write_b16_d16_hi v4, v147 offset:3824
    v_cvt_pk_bf16_f32 v146, -v134, -v142
    ds_write_b16 v4, v146 offset:3296
    ds_write_b16_d16_hi v4, v146 offset:3840
    v_cvt_pk_bf16_f32 v147, -v135, -v143
    ds_write_b16 v4, v147 offset:3312
    ds_write_b16_d16_hi v4, v147 offset:3856
    s_waitcnt lgkmcnt(0)
    ds_read_b128 v[100:103], v5 offset:2176
    ds_read_b128 v[104:107], v5 offset:3264
    buffer_store_dwordx4 v[148:151], v250, s[56:59], s82 offen sc1
    buffer_store_dwordx4 v[96:99], v250, s[56:59], s83 offen sc1
    s_waitcnt lgkmcnt(0)
    buffer_store_dwordx4 v[100:103], v250, s[56:59], s82 offen offset:1024 sc1
    buffer_store_dwordx4 v[104:107], v250, s[56:59], s83 offen offset:1024 sc1
    s_waitcnt lgkmcnt(0)
    s_add_u32 m0, s68, 32768
    s_add_u32 s70, s35, 32768
    buffer_load_dwordx4 v246, s[72:75], s35 offen lds
    buffer_load_dwordx4 v247, s[72:75], s35 offen offset:1024 lds
    buffer_load_dwordx4 v248, s[72:75], s35 offen offset:2048 lds
    buffer_load_dwordx4 v249, s[72:75], s35 offen offset:3072 lds
    s_add_u32 m0, s68, 49152
    s_nop 0
    buffer_load_dwordx4 v246, s[72:75], s70 offen lds
    buffer_load_dwordx4 v247, s[72:75], s70 offen offset:1024 lds
    buffer_load_dwordx4 v248, s[72:75], s70 offen offset:2048 lds
    buffer_load_dwordx4 v249, s[72:75], s70 offen offset:3072 lds
    s_add_u32 s35, s35, s48
    s_add_u32 m0, s68, 0
    s_add_u32 s70, s34, 32768
    buffer_load_dwordx4 v246, s[12:15], s34 offen lds
    buffer_load_dwordx4 v247, s[12:15], s34 offen offset:1024 lds
    buffer_load_dwordx4 v248, s[12:15], s34 offen offset:2048 lds
    buffer_load_dwordx4 v249, s[12:15], s34 offen offset:3072 lds
    s_add_u32 m0, s68, 16384
    s_nop 0
    buffer_load_dwordx4 v246, s[12:15], s70 offen lds
    buffer_load_dwordx4 v247, s[12:15], s70 offen offset:1024 lds
    buffer_load_dwordx4 v248, s[12:15], s70 offen offset:2048 lds
    buffer_load_dwordx4 v249, s[12:15], s70 offen offset:3072 lds
    s_add_u32 s34, s34, s48
    s_lshl_b32 s3, s4, 8
    s_lshl_b32 s7, s5, 2
    s_add_u32 s3, s3, s7
    s_add_u32 s3, s3, 11686144
    s_cmp_eq_u32 s6, 0
    s_cselect_b32 s7, 1, 0
    v_cmp_gt_u32 vcc, s7, v1
    v_mov_b32_e64 v4, s3
    v_mov_b32 v5, 0x7fffff00
    v_mov_b32_e64 v6, s95
    v_cndmask_b32_e64 v4, v5, v4, vcc
    s_waitcnt vmcnt(16)
    s_barrier
    buffer_store_dword v6, v4, s[56:59], 0 offen sc1
    s_add_u32 s3, s66, 384
    s_add_u32 s7, s69, 256
    s_add_u32 s71, s65, 393216
    s_add_u32 s82, s65, 327680
    s_mov_b32 s48, 0x20000
    s_bitcmp1_b32 s6, 0
    s_cselect_b32 s12, s28, s26
    s_cselect_b32 s13, s29, s27
    s_cselect_b32 s72, s26, s28
    s_cselect_b32 s73, s27, s29
    s_cmp_gt_i32 s90, 10
    s_cselect_b32 s12, s12, s40
    s_cselect_b32 s13, s13, s41
    s_cselect_b32 s72, s72, s40
    s_cselect_b32 s73, s73, s41
    s_cselect_b32 s34, s3, s71
    s_cselect_b32 s35, s7, s82
    s_cselect_b32 s48, 128, s48
    s_cselect_b64 vcc, -1, 0
    v_add_u32 v4, 0, v232
    v_add_u32_e64 v5, 0, v231
    v_cndmask_b32_e64 v246, v5, v4, vcc
    v_add_u32 v4, 7168, v233
    v_add_u32 v5, 7168, v231
    v_cndmask_b32_e64 v247, v5, v4, vcc
    v_add_u32 v4, 14336, v232
    v_add_u32 v5, 14336, v231
    v_cndmask_b32_e64 v248, v5, v4, vcc
    v_add_u32 v4, 21504, v233
    v_add_u32 v5, 21504, v231
    v_cndmask_b32_e64 v249, v5, v4, vcc
    s_add_u32 m0, s68, 98304
    s_add_u32 s70, s35, 32768
    buffer_load_dwordx4 v246, s[72:75], s35 offen lds
    buffer_load_dwordx4 v247, s[72:75], s35 offen offset:1024 lds
    buffer_load_dwordx4 v248, s[72:75], s35 offen offset:2048 lds
    buffer_load_dwordx4 v249, s[72:75], s35 offen offset:3072 lds
    s_add_u32 m0, s68, 114688
    s_nop 0
    buffer_load_dwordx4 v246, s[72:75], s70 offen lds
    buffer_load_dwordx4 v247, s[72:75], s70 offen offset:1024 lds
    buffer_load_dwordx4 v248, s[72:75], s70 offen offset:2048 lds
    buffer_load_dwordx4 v249, s[72:75], s70 offen offset:3072 lds
    s_add_u32 s35, s35, s48
    s_add_u32 m0, s68, 131072
    s_add_u32 s70, s34, 32768
    buffer_load_dwordx4 v246, s[12:15], s34 offen lds
    buffer_load_dwordx4 v247, s[12:15], s34 offen offset:1024 lds
    buffer_load_dwordx4 v248, s[12:15], s34 offen offset:2048 lds
    buffer_load_dwordx4 v249, s[12:15], s34 offen offset:3072 lds
    s_add_u32 m0, s68, 147456
    s_nop 0
    buffer_load_dwordx4 v246, s[12:15], s70 offen lds
    buffer_load_dwordx4 v247, s[12:15], s70 offen offset:1024 lds
    buffer_load_dwordx4 v248, s[12:15], s70 offen offset:2048 lds
    buffer_load_dwordx4 v249, s[12:15], s70 offen offset:3072 lds
    s_add_u32 s34, s34, s48
    s_waitcnt vmcnt(25)
    s_cmp_gt_i32 s90, 6
    s_cbranch_scc0 L_tr_10
    ds_read_b128 a[32:35], v234 offset:32768
    ds_read_b128 a[36:39], v234 offset:34816
    ds_read_b128 a[40:43], v234 offset:49152
    ds_read_b128 a[44:47], v234 offset:51200
    ds_read_b128 a[48:51], v239 offset:32768
    ds_read_b128 a[52:55], v239 offset:34816
    ds_read_b128 a[56:59], v239 offset:49152
    ds_read_b128 a[60:63], v239 offset:51200
    s_branch L_tj_11
L_tr_10:
    ds_read_b64_tr_b16 a[32:33], v235 offset:32768
    ds_read_b64_tr_b16 a[34:35], v235 offset:34816
    ds_read_b64_tr_b16 a[36:37], v236 offset:32768
    ds_read_b64_tr_b16 a[38:39], v236 offset:34816
    ds_read_b64_tr_b16 a[40:41], v237 offset:32768
    ds_read_b64_tr_b16 a[42:43], v237 offset:34816
    ds_read_b64_tr_b16 a[44:45], v238 offset:32768
    ds_read_b64_tr_b16 a[46:47], v238 offset:34816
    ds_read_b64_tr_b16 a[48:49], v235 offset:49152
    ds_read_b64_tr_b16 a[50:51], v235 offset:51200
    ds_read_b64_tr_b16 a[52:53], v236 offset:49152
    ds_read_b64_tr_b16 a[54:55], v236 offset:51200
    ds_read_b64_tr_b16 a[56:57], v237 offset:49152
    ds_read_b64_tr_b16 a[58:59], v237 offset:51200
    ds_read_b64_tr_b16 a[60:61], v238 offset:49152
    ds_read_b64_tr_b16 a[62:63], v238 offset:51200
L_tj_11:
    s_waitcnt lgkmcnt(0)
    s_add_u32 m0, s68, 32768
    s_add_u32 s70, s35, 32768
    buffer_load_dwordx4 v246, s[72:75], s35 offen lds
    buffer_load_dwordx4 v247, s[72:75], s35 offen offset:1024 lds
    buffer_load_dwordx4 v248, s[72:75], s35 offen offset:2048 lds
    buffer_load_dwordx4 v249, s[72:75], s35 offen offset:3072 lds
    s_add_u32 m0, s68, 49152
    s_nop 0
    buffer_load_dwordx4 v246, s[72:75], s70 offen lds
    buffer_load_dwordx4 v247, s[72:75], s70 offen offset:1024 lds
    buffer_load_dwordx4 v248, s[72:75], s70 offen offset:2048 lds
    buffer_load_dwordx4 v249, s[72:75], s70 offen offset:3072 lds
    s_add_u32 s35, s35, s48
    s_waitcnt vmcnt(25)
    s_cmp_gt_i32 s90, 8
    s_cbranch_scc0 L_tr_12
    ds_read_b128 a[64:67], v234 offset:0
    ds_read_b128 a[68:71], v234 offset:2048
    ds_read_b128 a[72:75], v234 offset:16384
    ds_read_b128 a[76:79], v234 offset:18432
    ds_read_b128 a[80:83], v239 offset:0
    ds_read_b128 a[84:87], v239 offset:2048
    ds_read_b128 a[88:91], v239 offset:16384
    ds_read_b128 a[92:95], v239 offset:18432
    s_branch L_tj_13
L_tr_12:
    ds_read_b64_tr_b16 a[64:65], v235 offset:0
    ds_read_b64_tr_b16 a[66:67], v235 offset:2048
    ds_read_b64_tr_b16 a[68:69], v236 offset:0
    ds_read_b64_tr_b16 a[70:71], v236 offset:2048
    ds_read_b64_tr_b16 a[72:73], v237 offset:0
    ds_read_b64_tr_b16 a[74:75], v237 offset:2048
    ds_read_b64_tr_b16 a[76:77], v238 offset:0
    ds_read_b64_tr_b16 a[78:79], v238 offset:2048
    ds_read_b64_tr_b16 a[80:81], v235 offset:16384
    ds_read_b64_tr_b16 a[82:83], v235 offset:18432
    ds_read_b64_tr_b16 a[84:85], v236 offset:16384
    ds_read_b64_tr_b16 a[86:87], v236 offset:18432
    ds_read_b64_tr_b16 a[88:89], v237 offset:16384
    ds_read_b64_tr_b16 a[90:91], v237 offset:18432
    ds_read_b64_tr_b16 a[92:93], v238 offset:16384
    ds_read_b64_tr_b16 a[94:95], v238 offset:18432
L_tj_13:
    s_waitcnt lgkmcnt(0)
    s_waitcnt vmcnt(16)
    s_cmp_gt_i32 s90, 10
    s_cbranch_scc0 L_tr_14
    ds_read_b128 a[96:99], v224 offset:0
    ds_read_b128 a[100:103], v224 offset:2048
    ds_read_b128 a[104:107], v224 offset:16384
    ds_read_b128 a[108:111], v224 offset:18432
    ds_read_b128 a[112:115], v230 offset:0
    ds_read_b128 a[116:119], v230 offset:2048
    ds_read_b128 a[120:123], v230 offset:16384
    ds_read_b128 a[124:127], v230 offset:18432
    s_branch L_tj_15
L_tr_14:
    ds_read_b64_tr_b16 a[96:97], v225 offset:0
    ds_read_b64_tr_b16 a[98:99], v225 offset:2048
    ds_read_b64_tr_b16 a[100:101], v226 offset:0
    ds_read_b64_tr_b16 a[102:103], v226 offset:2048
    ds_read_b64_tr_b16 a[104:105], v227 offset:0
    ds_read_b64_tr_b16 a[106:107], v227 offset:2048
    ds_read_b64_tr_b16 a[108:109], v228 offset:0
    ds_read_b64_tr_b16 a[110:111], v228 offset:2048
    ds_read_b64_tr_b16 a[112:113], v225 offset:16384
    ds_read_b64_tr_b16 a[114:115], v225 offset:18432
    ds_read_b64_tr_b16 a[116:117], v226 offset:16384
    ds_read_b64_tr_b16 a[118:119], v226 offset:18432
    ds_read_b64_tr_b16 a[120:121], v227 offset:16384
    ds_read_b64_tr_b16 a[122:123], v227 offset:18432
    ds_read_b64_tr_b16 a[124:125], v228 offset:16384
    ds_read_b64_tr_b16 a[126:127], v228 offset:18432
L_tj_15:
    s_waitcnt lgkmcnt(0)
    s_waitcnt vmcnt(8)
    s_cmp_gt_i32 s90, 12
    s_cbranch_scc0 L_tr_16
    ds_read_b128 a[128:131], v224 offset:32768
    ds_read_b128 a[132:135], v224 offset:34816
    ds_read_b128 a[136:139], v224 offset:49152
    ds_read_b128 a[140:143], v224 offset:51200
    ds_read_b128 a[144:147], v230 offset:32768
    ds_read_b128 a[148:151], v230 offset:34816
    ds_read_b128 a[152:155], v230 offset:49152
    ds_read_b128 a[156:159], v230 offset:51200
    s_branch L_tj_17
L_tr_16:
    ds_read_b64_tr_b16 a[128:129], v225 offset:32768
    ds_read_b64_tr_b16 a[130:131], v225 offset:34816
    ds_read_b64_tr_b16 a[132:133], v226 offset:32768
    ds_read_b64_tr_b16 a[134:135], v226 offset:34816
    ds_read_b64_tr_b16 a[136:137], v227 offset:32768
    ds_read_b64_tr_b16 a[138:139], v227 offset:34816
    ds_read_b64_tr_b16 a[140:141], v228 offset:32768
    ds_read_b64_tr_b16 a[142:143], v228 offset:34816
    ds_read_b64_tr_b16 a[144:145], v225 offset:49152
    ds_read_b64_tr_b16 a[146:147], v225 offset:51200
    ds_read_b64_tr_b16 a[148:149], v226 offset:49152
    ds_read_b64_tr_b16 a[150:151], v226 offset:51200
    ds_read_b64_tr_b16 a[152:153], v227 offset:49152
    ds_read_b64_tr_b16 a[154:155], v227 offset:51200
    ds_read_b64_tr_b16 a[156:157], v228 offset:49152
    ds_read_b64_tr_b16 a[158:159], v228 offset:51200
L_tj_17:
    s_waitcnt lgkmcnt(0)
    s_waitcnt vmcnt(0)
    s_cmp_gt_i32 s90, 14
    s_cbranch_scc0 L_tr_18
    ds_read_b128 a[160:163], v234 offset:32768
    ds_read_b128 a[164:167], v234 offset:34816
    ds_read_b128 a[168:171], v234 offset:49152
    ds_read_b128 a[172:175], v234 offset:51200
    ds_read_b128 a[176:179], v239 offset:32768
    ds_read_b128 a[180:183], v239 offset:34816
    ds_read_b128 a[184:187], v239 offset:49152
    ds_read_b128 a[188:191], v239 offset:51200
    s_branch L_tj_19
L_tr_18:
    ds_read_b64_tr_b16 a[160:161], v235 offset:32768
    ds_read_b64_tr_b16 a[162:163], v235 offset:34816
    ds_read_b64_tr_b16 a[164:165], v236 offset:32768
    ds_read_b64_tr_b16 a[166:167], v236 offset:34816
    ds_read_b64_tr_b16 a[168:169], v237 offset:32768
    ds_read_b64_tr_b16 a[170:171], v237 offset:34816
    ds_read_b64_tr_b16 a[172:173], v238 offset:32768
    ds_read_b64_tr_b16 a[174:175], v238 offset:34816
    ds_read_b64_tr_b16 a[176:177], v235 offset:49152
    ds_read_b64_tr_b16 a[178:179], v235 offset:51200
    ds_read_b64_tr_b16 a[180:181], v236 offset:49152
    ds_read_b64_tr_b16 a[182:183], v236 offset:51200
    ds_read_b64_tr_b16 a[184:185], v237 offset:49152
    ds_read_b64_tr_b16 a[186:187], v237 offset:51200
    ds_read_b64_tr_b16 a[188:189], v238 offset:49152
    ds_read_b64_tr_b16 a[190:191], v238 offset:51200
L_tj_19:
    s_waitcnt lgkmcnt(0)
    s_mov_b32 s92, s64
    s_mul_i32 s93, s92, 360448
    s_mul_i32 s3, s6, 90112
    s_add_u32 s93, s93, s3
    v_lshlrev_b32 v8, 4, v1
    s_lshr_b32 s3, s92, 1
    s_lshl_b32 s3, s3, 8
    s_add_u32 s3, s3, 11686144
    v_and_b32 v4, 15, v1
    v_lshl_add_u32 v9, v4, 2, s3
    s_mov_b32 s96, 0x20000
L_fpoll_20:
    buffer_load_dword v10, v9, s[56:59], 0 offen sc1
    s_waitcnt vmcnt(0)
    v_cmp_ne_u32_e64 vcc, s95, v10
    s_nop 3
    s_cmp_eq_u64 vcc, 0
    s_cbranch_scc1 L_fok_21
    s_sub_u32 s96, s96, 1
    s_cmp_eq_u32 s96, 0
    s_cbranch_scc1 L_fok_21
    s_sleep 1
    s_branch L_fpoll_20
L_fok_21:
    buffer_load_dwordx4 v[80:83], v8, s[56:59], s93 offen sc1
    buffer_load_dwordx4 v[84:87], v8, s[56:59], s93 offen offset:1024 sc1
    buffer_load_dwordx4 v[88:91], v8, s[56:59], s93 offen offset:2048 sc1
    buffer_load_dwordx4 v[92:95], v8, s[56:59], s93 offen offset:3072 sc1
    s_add_u32 s93, s93, 4096
    buffer_load_dwordx4 v[96:99], v8, s[56:59], s93 offen sc1
    buffer_load_dwordx4 v[100:103], v8, s[56:59], s93 offen offset:1024 sc1
    buffer_load_dwordx4 v[104:107], v8, s[56:59], s93 offen offset:2048 sc1
    buffer_load_dwordx4 v[108:111], v8, s[56:59], s93 offen offset:3072 sc1
    s_add_u32 s93, s93, 4096
    s_cmp_eq_u32 s92, 31
    s_cselect_b32 s3, 1, 0
    s_cmp_eq_u32 s89, 7
    s_cselect_b32 s3, s3, 0
    s_cmp_eq_u32 s6, 0
    s_cselect_b32 s3, s3, 0
    v_cmp_gt_u32_e64 vcc, s3, v1
    v_mov_b32 v4, 11681792
    v_mov_b32 v5, 0x7fffff00
    v_mov_b32 v6, s94
    v_cndmask_b32 v4, v5, v4, vcc
    buffer_store_dword v6, v4, s[56:59], 0 offen sc1
    v_lshrrev_b32 v6, 2, v2
    v_lshlrev_b32 v6, 3, v6
    v_and_b32 v7, 3, v2
    v_add_u32 v6, v6, v7
    v_lshlrev_b32_e64 v6, 8, v6
    s_mul_i32 s3, s6, 16384
    s_add_u32 s3, s3, 65536
    v_add_u32_e64 v6, s3, v6
    v_and_b32_e64 v7, 7, v2
    v_xor_b32_e64 v7, v7, v3
    v_lshl_add_u32 v13, v7, 4, v6
    v_xor_b32_e64 v7, 4, v7
    v_lshl_add_u32 v15, v7, 4, v6
    s_add_u32 m0, s68, 32768
    s_add_u32 s70, s34, 32768
    buffer_load_dwordx4 v246, s[12:15], s34 offen lds
    buffer_load_dwordx4 v247, s[12:15], s34 offen offset:1024 lds
    buffer_load_dwordx4 v248, s[12:15], s34 offen offset:2048 lds
    buffer_load_dwordx4 v249, s[12:15], s34 offen offset:3072 lds
    s_add_u32 m0, s68, 49152
    s_nop 0
    buffer_load_dwordx4 v246, s[12:15], s70 offen lds
    buffer_load_dwordx4 v247, s[12:15], s70 offen offset:1024 lds
    buffer_load_dwordx4 v248, s[12:15], s70 offen offset:2048 lds
    buffer_load_dwordx4 v249, s[12:15], s70 offen offset:3072 lds
    s_add_u32 s34, s34, s48
    s_waitcnt vmcnt(13)
    v_mfma_f32_16x16x32_bf16 v[16:19], a[192:195], v[80:83], 0
    v_mfma_f32_16x16x32_bf16 v[20:23], a[192:195], v[84:87], 0
    buffer_load_dwordx4 v[112:115], v8, s[56:59], s93 offen sc1
    v_mfma_f32_16x16x32_bf16 v[24:27], a[192:195], v[88:91], 0
    v_mfma_f32_16x16x32_bf16 v[28:31], a[192:195], v[92:95], 0
    buffer_load_dwordx4 v[116:119], v8, s[56:59], s93 offen offset:1024 sc1
    v_mfma_f32_16x16x32_bf16 v[32:35], a[196:199], v[80:83], 0
    v_mfma_f32_16x16x32_bf16 v[36:39], a[196:199], v[84:87], 0
    buffer_load_dwordx4 v[120:123], v8, s[56:59], s93 offen offset:2048 sc1
    v_mfma_f32_16x16x32_bf16 v[40:43], a[196:199], v[88:91], 0
    v_mfma_f32_16x16x32_bf16 v[44:47], a[196:199], v[92:95], 0
    buffer_load_dwordx4 v[124:127], v8, s[56:59], s93 offen offset:3072 sc1
    v_mfma_f32_16x16x32_bf16 v[48:51], a[200:203], v[80:83], 0
    v_mfma_f32_16x16x32_bf16 v[52:55], a[200:203], v[84:87], 0
    v_mfma_f32_16x16x32_bf16 v[56:59], a[200:203], v[88:91], 0
    v_mfma_f32_16x16x32_bf16 v[60:63], a[200:203], v[92:95], 0
    v_mfma_f32_16x16x32_bf16 v[64:67], a[204:207], v[80:83], 0
    v_mfma_f32_16x16x32_bf16 v[68:71], a[204:207], v[84:87], 0
    v_mfma_f32_16x16x32_bf16 v[72:75], a[204:207], v[88:91], 0
    v_mfma_f32_16x16x32_bf16 v[76:79], a[204:207], v[92:95], 0
    s_add_u32 s93, s93, 4096
    s_waitcnt vmcnt(13)
    v_mfma_f32_16x16x32_bf16 v[16:19], a[208:211], v[96:99], v[16:19]
    v_mfma_f32_16x16x32_bf16 v[20:23], a[208:211], v[100:103], v[20:23]
    buffer_load_dwordx4 v[80:83], v8, s[56:59], s93 offen sc1
    v_mfma_f32_16x16x32_bf16 v[24:27], a[208:211], v[104:107], v[24:27]
    v_mfma_f32_16x16x32_bf16 v[28:31], a[208:211], v[108:111], v[28:31]
    buffer_load_dwordx4 v[84:87], v8, s[56:59], s93 offen offset:1024 sc1
    v_mfma_f32_16x16x32_bf16 v[32:35], a[212:215], v[96:99], v[32:35]
    v_mfma_f32_16x16x32_bf16 v[36:39], a[212:215], v[100:103], v[36:39]
    buffer_load_dwordx4 v[88:91], v8, s[56:59], s93 offen offset:2048 sc1
    v_mfma_f32_16x16x32_bf16 v[40:43], a[212:215], v[104:107], v[40:43]
    v_mfma_f32_16x16x32_bf16 v[44:47], a[212:215], v[108:111], v[44:47]
    buffer_load_dwordx4 v[92:95], v8, s[56:59], s93 offen offset:3072 sc1
    v_mfma_f32_16x16x32_bf16 v[48:51], a[216:219], v[96:99], v[48:51]
    v_mfma_f32_16x16x32_bf16 v[52:55], a[216:219], v[100:103], v[52:55]
    v_mfma_f32_16x16x32_bf16 v[56:59], a[216:219], v[104:107], v[56:59]
    v_mfma_f32_16x16x32_bf16 v[60:63], a[216:219], v[108:111], v[60:63]
    v_mfma_f32_16x16x32_bf16 v[64:67], a[220:223], v[96:99], v[64:67]
    v_mfma_f32_16x16x32_bf16 v[68:71], a[220:223], v[100:103], v[68:71]
    v_mfma_f32_16x16x32_bf16 v[72:75], a[220:223], v[104:107], v[72:75]
    v_mfma_f32_16x16x32_bf16 v[76:79], a[220:223], v[108:111], v[76:79]
    s_add_u32 s93, s93, 4096
    s_add_u32 m0, s68, 0
    s_add_u32 s70, s35, 32768
    buffer_load_dwordx4 v246, s[72:75], s35 offen lds
    buffer_load_dwordx4 v247, s[72:75], s35 offen offset:1024 lds
    buffer_load_dwordx4 v248, s[72:75], s35 offen offset:2048 lds
    buffer_load_dwordx4 v249, s[72:75], s35 offen offset:3072 lds
    s_add_u32 m0, s68, 16384
    s_nop 0
    buffer_load_dwordx4 v246, s[72:75], s70 offen lds
    buffer_load_dwordx4 v247, s[72:75], s70 offen offset:1024 lds
    buffer_load_dwordx4 v248, s[72:75], s70 offen offset:2048 lds
    buffer_load_dwordx4 v249, s[72:75], s70 offen offset:3072 lds
    s_add_u32 s35, s35, s48
    s_waitcnt vmcnt(12)
    v_mfma_f32_16x16x32_bf16 v[16:19], a[224:227], v[112:115], v[16:19]
    v_mfma_f32_16x16x32_bf16 v[20:23], a[224:227], v[116:119], v[20:23]
    buffer_load_dwordx4 v[96:99], v8, s[56:59], s93 offen sc1
    v_mfma_f32_16x16x32_bf16 v[24:27], a[224:227], v[120:123], v[24:27]
    v_mfma_f32_16x16x32_bf16 v[28:31], a[224:227], v[124:127], v[28:31]
    buffer_load_dwordx4 v[100:103], v8, s[56:59], s93 offen offset:1024 sc1
    v_mfma_f32_16x16x32_bf16 v[32:35], a[228:231], v[112:115], v[32:35]
    v_mfma_f32_16x16x32_bf16 v[36:39], a[228:231], v[116:119], v[36:39]
    buffer_load_dwordx4 v[104:107], v8, s[56:59], s93 offen offset:2048 sc1
    v_mfma_f32_16x16x32_bf16 v[40:43], a[228:231], v[120:123], v[40:43]
    v_mfma_f32_16x16x32_bf16 v[44:47], a[228:231], v[124:127], v[44:47]
    buffer_load_dwordx4 v[108:111], v8, s[56:59], s93 offen offset:3072 sc1
    v_mfma_f32_16x16x32_bf16 v[48:51], a[232:235], v[112:115], v[48:51]
    v_mfma_f32_16x16x32_bf16 v[52:55], a[232:235], v[116:119], v[52:55]
    v_mfma_f32_16x16x32_bf16 v[56:59], a[232:235], v[120:123], v[56:59]
    v_mfma_f32_16x16x32_bf16 v[60:63], a[232:235], v[124:127], v[60:63]
    v_mfma_f32_16x16x32_bf16 v[64:67], a[236:239], v[112:115], v[64:67]
    v_mfma_f32_16x16x32_bf16 v[68:71], a[236:239], v[116:119], v[68:71]
    v_mfma_f32_16x16x32_bf16 v[72:75], a[236:239], v[120:123], v[72:75]
    v_mfma_f32_16x16x32_bf16 v[76:79], a[236:239], v[124:127], v[76:79]
    s_add_u32 s93, s93, 4096
    s_waitcnt vmcnt(12)
    v_mfma_f32_16x16x32_bf16 v[16:19], a[240:243], v[80:83], v[16:19]
    v_mfma_f32_16x16x32_bf16 v[20:23], a[240:243], v[84:87], v[20:23]
    buffer_load_dwordx4 v[112:115], v8, s[56:59], s93 offen sc1
    v_mfma_f32_16x16x32_bf16 v[24:27], a[240:243], v[88:91], v[24:27]
    v_mfma_f32_16x16x32_bf16 v[28:31], a[240:243], v[92:95], v[28:31]
    buffer_load_dwordx4 v[116:119], v8, s[56:59], s93 offen offset:1024 sc1
    v_mfma_f32_16x16x32_bf16 v[32:35], a[244:247], v[80:83], v[32:35]
    v_mfma_f32_16x16x32_bf16 v[36:39], a[244:247], v[84:87], v[36:39]
    buffer_load_dwordx4 v[120:123], v8, s[56:59], s93 offen offset:2048 sc1
    v_mfma_f32_16x16x32_bf16 v[40:43], a[244:247], v[88:91], v[40:43]
    v_mfma_f32_16x16x32_bf16 v[44:47], a[244:247], v[92:95], v[44:47]
    buffer_load_dwordx4 v[124:127], v8, s[56:59], s93 offen offset:3072 sc1
    v_mfma_f32_16x16x32_bf16 v[48:51], a[248:251], v[80:83], v[48:51]
    v_mfma_f32_16x16x32_bf16 v[52:55], a[248:251], v[84:87], v[52:55]
    v_mfma_f32_16x16x32_bf16 v[56:59], a[248:251], v[88:91], v[56:59]
    v_mfma_f32_16x16x32_bf16 v[60:63], a[248:251], v[92:95], v[60:63]
    v_mfma_f32_16x16x32_bf16 v[64:67], a[252:255], v[80:83], v[64:67]
    v_mfma_f32_16x16x32_bf16 v[68:71], a[252:255], v[84:87], v[68:71]
    v_mfma_f32_16x16x32_bf16 v[72:75], a[252:255], v[88:91], v[72:75]
    v_mfma_f32_16x16x32_bf16 v[76:79], a[252:255], v[92:95], v[76:79]
    s_add_u32 s93, s93, 4096
    s_cmp_gt_i32 s90, 16
    s_cbranch_scc0 L_tr_22
    ds_read_b128 v[128:131], v234 offset:32768
    ds_read_b128 v[132:135], v234 offset:34816
    ds_read_b128 v[136:139], v234 offset:49152
    ds_read_b128 v[140:143], v234 offset:51200
    ds_read_b128 v[144:147], v239 offset:32768
    ds_read_b128 v[148:151], v239 offset:34816
    ds_read_b128 v[152:155], v239 offset:49152
    ds_read_b128 v[156:159], v239 offset:51200
    s_branch L_tj_23
L_tr_22:
    ds_read_b64_tr_b16 v[128:129], v235 offset:32768
    ds_read_b64_tr_b16 v[130:131], v235 offset:34816
    ds_read_b64_tr_b16 v[132:133], v236 offset:32768
    ds_read_b64_tr_b16 v[134:135], v236 offset:34816
    ds_read_b64_tr_b16 v[136:137], v237 offset:32768
    ds_read_b64_tr_b16 v[138:139], v237 offset:34816
    ds_read_b64_tr_b16 v[140:141], v238 offset:32768
    ds_read_b64_tr_b16 v[142:143], v238 offset:34816
    ds_read_b64_tr_b16 v[144:145], v235 offset:49152
    ds_read_b64_tr_b16 v[146:147], v235 offset:51200
    ds_read_b64_tr_b16 v[148:149], v236 offset:49152
    ds_read_b64_tr_b16 v[150:151], v236 offset:51200
    ds_read_b64_tr_b16 v[152:153], v237 offset:49152
    ds_read_b64_tr_b16 v[154:155], v237 offset:51200
    ds_read_b64_tr_b16 v[156:157], v238 offset:49152
    ds_read_b64_tr_b16 v[158:159], v238 offset:51200
L_tj_23:
    s_waitcnt lgkmcnt(0)
    s_add_u32 m0, s68, 32768
    s_add_u32 s70, s34, 32768
    buffer_load_dwordx4 v246, s[12:15], s34 offen lds
    buffer_load_dwordx4 v247, s[12:15], s34 offen offset:1024 lds
    buffer_load_dwordx4 v248, s[12:15], s34 offen offset:2048 lds
    buffer_load_dwordx4 v249, s[12:15], s34 offen offset:3072 lds
    s_add_u32 m0, s68, 49152
    s_nop 0
    buffer_load_dwordx4 v246, s[12:15], s70 offen lds
    buffer_load_dwordx4 v247, s[12:15], s70 offen offset:1024 lds
    buffer_load_dwordx4 v248, s[12:15], s70 offen offset:2048 lds
    buffer_load_dwordx4 v249, s[12:15], s70 offen offset:3072 lds
    s_add_u32 s34, s34, s48
    s_waitcnt vmcnt(12)
    v_mfma_f32_16x16x32_bf16 v[16:19], a[0:3], v[96:99], v[16:19]
    v_mfma_f32_16x16x32_bf16 v[20:23], a[0:3], v[100:103], v[20:23]
    buffer_load_dwordx4 v[80:83], v8, s[56:59], s93 offen sc1
    v_mfma_f32_16x16x32_bf16 v[24:27], a[0:3], v[104:107], v[24:27]
    v_mfma_f32_16x16x32_bf16 v[28:31], a[0:3], v[108:111], v[28:31]
    buffer_load_dwordx4 v[84:87], v8, s[56:59], s93 offen offset:1024 sc1
    v_mfma_f32_16x16x32_bf16 v[32:35], a[4:7], v[96:99], v[32:35]
    v_mfma_f32_16x16x32_bf16 v[36:39], a[4:7], v[100:103], v[36:39]
    buffer_load_dwordx4 v[88:91], v8, s[56:59], s93 offen offset:2048 sc1
    v_mfma_f32_16x16x32_bf16 v[40:43], a[4:7], v[104:107], v[40:43]
    v_mfma_f32_16x16x32_bf16 v[44:47], a[4:7], v[108:111], v[44:47]
    buffer_load_dwordx4 v[92:95], v8, s[56:59], s93 offen offset:3072 sc1
    v_mfma_f32_16x16x32_bf16 v[48:51], a[8:11], v[96:99], v[48:51]
    v_mfma_f32_16x16x32_bf16 v[52:55], a[8:11], v[100:103], v[52:55]
    v_mfma_f32_16x16x32_bf16 v[56:59], a[8:11], v[104:107], v[56:59]
    v_mfma_f32_16x16x32_bf16 v[60:63], a[8:11], v[108:111], v[60:63]
    v_mfma_f32_16x16x32_bf16 v[64:67], a[12:15], v[96:99], v[64:67]
    v_mfma_f32_16x16x32_bf16 v[68:71], a[12:15], v[100:103], v[68:71]
    v_mfma_f32_16x16x32_bf16 v[72:75], a[12:15], v[104:107], v[72:75]
    v_mfma_f32_16x16x32_bf16 v[76:79], a[12:15], v[108:111], v[76:79]
    s_add_u32 s93, s93, 4096
    s_waitcnt vmcnt(12)
    v_mfma_f32_16x16x32_bf16 v[16:19], a[16:19], v[112:115], v[16:19]
    v_mfma_f32_16x16x32_bf16 v[20:23], a[16:19], v[116:119], v[20:23]
    buffer_load_dwordx4 v[96:99], v8, s[56:59], s93 offen sc1
    v_mfma_f32_16x16x32_bf16 v[24:27], a[16:19], v[120:123], v[24:27]
    v_mfma_f32_16x16x32_bf16 v[28:31], a[16:19], v[124:127], v[28:31]
    buffer_load_dwordx4 v[100:103], v8, s[56:59], s93 offen offset:1024 sc1
    v_mfma_f32_16x16x32_bf16 v[32:35], a[20:23], v[112:115], v[32:35]
    v_mfma_f32_16x16x32_bf16 v[36:39], a[20:23], v[116:119], v[36:39]
    buffer_load_dwordx4 v[104:107], v8, s[56:59], s93 offen offset:2048 sc1
    v_mfma_f32_16x16x32_bf16 v[40:43], a[20:23], v[120:123], v[40:43]
    v_mfma_f32_16x16x32_bf16 v[44:47], a[20:23], v[124:127], v[44:47]
    buffer_load_dwordx4 v[108:111], v8, s[56:59], s93 offen offset:3072 sc1
    v_mfma_f32_16x16x32_bf16 v[48:51], a[24:27], v[112:115], v[48:51]
    v_mfma_f32_16x16x32_bf16 v[52:55], a[24:27], v[116:119], v[52:55]
    v_mfma_f32_16x16x32_bf16 v[56:59], a[24:27], v[120:123], v[56:59]
    v_mfma_f32_16x16x32_bf16 v[60:63], a[24:27], v[124:127], v[60:63]
    v_mfma_f32_16x16x32_bf16 v[64:67], a[28:31], v[112:115], v[64:67]
    v_mfma_f32_16x16x32_bf16 v[68:71], a[28:31], v[116:119], v[68:71]
    v_mfma_f32_16x16x32_bf16 v[72:75], a[28:31], v[120:123], v[72:75]
    v_mfma_f32_16x16x32_bf16 v[76:79], a[28:31], v[124:127], v[76:79]
    s_add_u32 s93, s93, 4096
    s_cmp_gt_i32 s90, 18
    s_cbranch_scc0 L_tr_24
    ds_read_b128 v[160:163], v234 offset:0
    ds_read_b128 v[164:167], v234 offset:2048
    ds_read_b128 v[168:171], v234 offset:16384
    ds_read_b128 v[172:175], v234 offset:18432
    ds_read_b128 v[176:179], v239 offset:0
    ds_read_b128 v[180:183], v239 offset:2048
    ds_read_b128 v[184:187], v239 offset:16384
    ds_read_b128 v[188:191], v239 offset:18432
    s_branch L_tj_25
L_tr_24:
    ds_read_b64_tr_b16 v[160:161], v235 offset:0
    ds_read_b64_tr_b16 v[162:163], v235 offset:2048
    ds_read_b64_tr_b16 v[164:165], v236 offset:0
    ds_read_b64_tr_b16 v[166:167], v236 offset:2048
    ds_read_b64_tr_b16 v[168:169], v237 offset:0
    ds_read_b64_tr_b16 v[170:171], v237 offset:2048
    ds_read_b64_tr_b16 v[172:173], v238 offset:0
    ds_read_b64_tr_b16 v[174:175], v238 offset:2048
    ds_read_b64_tr_b16 v[176:177], v235 offset:16384
    ds_read_b64_tr_b16 v[178:179], v235 offset:18432
    ds_read_b64_tr_b16 v[180:181], v236 offset:16384
    ds_read_b64_tr_b16 v[182:183], v236 offset:18432
    ds_read_b64_tr_b16 v[184:185], v237 offset:16384
    ds_read_b64_tr_b16 v[186:187], v237 offset:18432
    ds_read_b64_tr_b16 v[188:189], v238 offset:16384
    ds_read_b64_tr_b16 v[190:191], v238 offset:18432
L_tj_25:
    s_waitcnt lgkmcnt(0)
    s_waitcnt vmcnt(4)
    v_mfma_f32_16x16x32_bf16 v[16:19], a[32:35], v[80:83], v[16:19]
    v_mfma_f32_16x16x32_bf16 v[20:23], a[32:35], v[84:87], v[20:23]
    buffer_load_dwordx4 v[112:115], v8, s[56:59], s93 offen sc1
    v_mfma_f32_16x16x32_bf16 v[24:27], a[32:35], v[88:91], v[24:27]
    v_mfma_f32_16x16x32_bf16 v[28:31], a[32:35], v[92:95], v[28:31]
    buffer_load_dwordx4 v[116:119], v8, s[56:59], s93 offen offset:1024 sc1
    v_mfma_f32_16x16x32_bf16 v[32:35], a[36:39], v[80:83], v[32:35]
    v_mfma_f32_16x16x32_bf16 v[36:39], a[36:39], v[84:87], v[36:39]
    buffer_load_dwordx4 v[120:123], v8, s[56:59], s93 offen offset:2048 sc1
    v_mfma_f32_16x16x32_bf16 v[40:43], a[36:39], v[88:91], v[40:43]
    v_mfma_f32_16x16x32_bf16 v[44:47], a[36:39], v[92:95], v[44:47]
    buffer_load_dwordx4 v[124:127], v8, s[56:59], s93 offen offset:3072 sc1
    v_mfma_f32_16x16x32_bf16 v[48:51], a[40:43], v[80:83], v[48:51]
    v_mfma_f32_16x16x32_bf16 v[52:55], a[40:43], v[84:87], v[52:55]
    v_mfma_f32_16x16x32_bf16 v[56:59], a[40:43], v[88:91], v[56:59]
    v_mfma_f32_16x16x32_bf16 v[60:63], a[40:43], v[92:95], v[60:63]
    v_mfma_f32_16x16x32_bf16 v[64:67], a[44:47], v[80:83], v[64:67]
    v_mfma_f32_16x16x32_bf16 v[68:71], a[44:47], v[84:87], v[68:71]
    v_mfma_f32_16x16x32_bf16 v[72:75], a[44:47], v[88:91], v[72:75]
    v_mfma_f32_16x16x32_bf16 v[76:79], a[44:47], v[92:95], v[76:79]
    s_add_u32 s93, s93, 4096
    s_waitcnt vmcnt(4)
    v_mfma_f32_16x16x32_bf16 v[16:19], a[48:51], v[96:99], v[16:19]
    v_mfma_f32_16x16x32_bf16 v[20:23], a[48:51], v[100:103], v[20:23]
    buffer_load_dwordx4 v[80:83], v8, s[56:59], s93 offen sc1
    v_mfma_f32_16x16x32_bf16 v[24:27], a[48:51], v[104:107], v[24:27]
    v_mfma_f32_16x16x32_bf16 v[28:31], a[48:51], v[108:111], v[28:31]
    buffer_load_dwordx4 v[84:87], v8, s[56:59], s93 offen offset:1024 sc1
    v_mfma_f32_16x16x32_bf16 v[32:35], a[52:55], v[96:99], v[32:35]
    v_mfma_f32_16x16x32_bf16 v[36:39], a[52:55], v[100:103], v[36:39]
    buffer_load_dwordx4 v[88:91], v8, s[56:59], s93 offen offset:2048 sc1
    v_mfma_f32_16x16x32_bf16 v[40:43], a[52:55], v[104:107], v[40:43]
    v_mfma_f32_16x16x32_bf16 v[44:47], a[52:55], v[108:111], v[44:47]
    buffer_load_dwordx4 v[92:95], v8, s[56:59], s93 offen offset:3072 sc1
    v_mfma_f32_16x16x32_bf16 v[48:51], a[56:59], v[96:99], v[48:51]
    v_mfma_f32_16x16x32_bf16 v[52:55], a[56:59], v[100:103], v[52:55]
    v_mfma_f32_16x16x32_bf16 v[56:59], a[56:59], v[104:107], v[56:59]
    v_mfma_f32_16x16x32_bf16 v[60:63], a[56:59], v[108:111], v[60:63]
    v_mfma_f32_16x16x32_bf16 v[64:67], a[60:63], v[96:99], v[64:67]
    v_mfma_f32_16x16x32_bf16 v[68:71], a[60:63], v[100:103], v[68:71]
    v_mfma_f32_16x16x32_bf16 v[72:75], a[60:63], v[104:107], v[72:75]
    v_mfma_f32_16x16x32_bf16 v[76:79], a[60:63], v[108:111], v[76:79]
    s_add_u32 s93, s93, 4096
    s_cmp_gt_i32 s90, 20
    s_cbranch_scc0 L_tr_26
    ds_read_b128 v[192:195], v234 offset:32768
    ds_read_b128 v[196:199], v234 offset:34816
    ds_read_b128 v[200:203], v234 offset:49152
    ds_read_b128 v[204:207], v234 offset:51200
    ds_read_b128 v[208:211], v239 offset:32768
    ds_read_b128 v[212:215], v239 offset:34816
    ds_read_b128 v[216:219], v239 offset:49152
    ds_read_b128 v[220:223], v239 offset:51200
    s_branch L_tj_27
L_tr_26:
    ds_read_b64_tr_b16 v[192:193], v235 offset:32768
    ds_read_b64_tr_b16 v[194:195], v235 offset:34816
    ds_read_b64_tr_b16 v[196:197], v236 offset:32768
    ds_read_b64_tr_b16 v[198:199], v236 offset:34816
    ds_read_b64_tr_b16 v[200:201], v237 offset:32768
    ds_read_b64_tr_b16 v[202:203], v237 offset:34816
    ds_read_b64_tr_b16 v[204:205], v238 offset:32768
    ds_read_b64_tr_b16 v[206:207], v238 offset:34816
    ds_read_b64_tr_b16 v[208:209], v235 offset:49152
    ds_read_b64_tr_b16 v[210:211], v235 offset:51200
    ds_read_b64_tr_b16 v[212:213], v236 offset:49152
    ds_read_b64_tr_b16 v[214:215], v236 offset:51200
    ds_read_b64_tr_b16 v[216:217], v237 offset:49152
    ds_read_b64_tr_b16 v[218:219], v237 offset:51200
    ds_read_b64_tr_b16 v[220:221], v238 offset:49152
    ds_read_b64_tr_b16 v[222:223], v238 offset:51200
L_tj_27:
    s_waitcnt lgkmcnt(0)
    s_waitcnt vmcnt(4)
    v_mfma_f32_16x16x32_bf16 v[16:19], a[64:67], v[112:115], v[16:19]
    v_mfma_f32_16x16x32_bf16 v[20:23], a[64:67], v[116:119], v[20:23]
    buffer_load_dwordx4 v[96:99], v8, s[56:59], s93 offen sc1
    v_mfma_f32_16x16x32_bf16 v[24:27], a[64:67], v[120:123], v[24:27]
    v_mfma_f32_16x16x32_bf16 v[28:31], a[64:67], v[124:127], v[28:31]
    buffer_load_dwordx4 v[100:103], v8, s[56:59], s93 offen offset:1024 sc1
    v_mfma_f32_16x16x32_bf16 v[32:35], a[68:71], v[112:115], v[32:35]
    v_mfma_f32_16x16x32_bf16 v[36:39], a[68:71], v[116:119], v[36:39]
    buffer_load_dwordx4 v[104:107], v8, s[56:59], s93 offen offset:2048 sc1
    v_mfma_f32_16x16x32_bf16 v[40:43], a[68:71], v[120:123], v[40:43]
    v_mfma_f32_16x16x32_bf16 v[44:47], a[68:71], v[124:127], v[44:47]
    buffer_load_dwordx4 v[108:111], v8, s[56:59], s93 offen offset:3072 sc1
    v_mfma_f32_16x16x32_bf16 v[48:51], a[72:75], v[112:115], v[48:51]
    v_mfma_f32_16x16x32_bf16 v[52:55], a[72:75], v[116:119], v[52:55]
    v_mfma_f32_16x16x32_bf16 v[56:59], a[72:75], v[120:123], v[56:59]
    v_mfma_f32_16x16x32_bf16 v[60:63], a[72:75], v[124:127], v[60:63]
    v_mfma_f32_16x16x32_bf16 v[64:67], a[76:79], v[112:115], v[64:67]
    v_mfma_f32_16x16x32_bf16 v[68:71], a[76:79], v[116:119], v[68:71]
    v_mfma_f32_16x16x32_bf16 v[72:75], a[76:79], v[120:123], v[72:75]
    v_mfma_f32_16x16x32_bf16 v[76:79], a[76:79], v[124:127], v[76:79]
    s_add_u32 s93, s93, 4096
    s_barrier
    s_waitcnt vmcnt(4)
    v_mfma_f32_16x16x32_bf16 v[16:19], a[80:83], v[80:83], v[16:19]
    v_mfma_f32_16x16x32_bf16 v[20:23], a[80:83], v[84:87], v[20:23]
    buffer_load_dwordx4 v[112:115], v8, s[56:59], s93 offen sc1
    v_mfma_f32_16x16x32_bf16 v[24:27], a[80:83], v[88:91], v[24:27]
    v_mfma_f32_16x16x32_bf16 v[28:31], a[80:83], v[92:95], v[28:31]
    buffer_load_dwordx4 v[116:119], v8, s[56:59], s93 offen offset:1024 sc1
    v_mfma_f32_16x16x32_bf16 v[32:35], a[84:87], v[80:83], v[32:35]
    v_mfma_f32_16x16x32_bf16 v[36:39], a[84:87], v[84:87], v[36:39]
    buffer_load_dwordx4 v[120:123], v8, s[56:59], s93 offen offset:2048 sc1
    v_mfma_f32_16x16x32_bf16 v[40:43], a[84:87], v[88:91], v[40:43]
    v_mfma_f32_16x16x32_bf16 v[44:47], a[84:87], v[92:95], v[44:47]
    buffer_load_dwordx4 v[124:127], v8, s[56:59], s93 offen offset:3072 sc1
    v_mfma_f32_16x16x32_bf16 v[48:51], a[88:91], v[80:83], v[48:51]
    v_mfma_f32_16x16x32_bf16 v[52:55], a[88:91], v[84:87], v[52:55]
    v_mfma_f32_16x16x32_bf16 v[56:59], a[88:91], v[88:91], v[56:59]
    v_mfma_f32_16x16x32_bf16 v[60:63], a[88:91], v[92:95], v[60:63]
    v_mfma_f32_16x16x32_bf16 v[64:67], a[92:95], v[80:83], v[64:67]
    v_mfma_f32_16x16x32_bf16 v[68:71], a[92:95], v[84:87], v[68:71]
    v_mfma_f32_16x16x32_bf16 v[72:75], a[92:95], v[88:91], v[72:75]
    v_mfma_f32_16x16x32_bf16 v[76:79], a[92:95], v[92:95], v[76:79]
    s_add_u32 s93, s93, 4096
    s_waitcnt vmcnt(4)
    s_cmp_eq_u32 s6, 1
    s_cbranch_scc0 L_nrm_28
    s_nop 7
    ds_write_b128 v13, v[16:19] offset:49152
    ds_write_b128 v13, v[20:23] offset:50176
    ds_write_b128 v13, v[24:27] offset:57344
    v_mfma_f32_16x16x32_bf16 v[16:19], a[96:99], v[96:99], 0
    ds_write_b128 v13, v[28:31] offset:58368
    v_mfma_f32_16x16x32_bf16 v[20:23], a[96:99], v[100:103], 0
    buffer_load_dwordx4 v[80:83], v8, s[56:59], s93 offen sc1
    ds_write_b128 v15, v[32:35] offset:49152
    v_mfma_f32_16x16x32_bf16 v[24:27], a[96:99], v[104:107], 0
    ds_write_b128 v15, v[36:39] offset:50176
    v_mfma_f32_16x16x32_bf16 v[28:31], a[96:99], v[108:111], 0
    buffer_load_dwordx4 v[84:87], v8, s[56:59], s93 offen offset:1024 sc1
    ds_write_b128 v15, v[40:43] offset:57344
    v_mfma_f32_16x16x32_bf16 v[32:35], a[100:103], v[96:99], 0
    ds_write_b128 v15, v[44:47] offset:58368
    v_mfma_f32_16x16x32_bf16 v[36:39], a[100:103], v[100:103], 0
    buffer_load_dwordx4 v[88:91], v8, s[56:59], s93 offen offset:2048 sc1
    ds_write_b128 v13, v[48:51] offset:49280
    v_mfma_f32_16x16x32_bf16 v[40:43], a[100:103], v[104:107], 0
    ds_write_b128 v13, v[52:55] offset:50304
    v_mfma_f32_16x16x32_bf16 v[44:47], a[100:103], v[108:111], 0
    buffer_load_dwordx4 v[92:95], v8, s[56:59], s93 offen offset:3072 sc1
    ds_write_b128 v13, v[56:59] offset:57472
    v_mfma_f32_16x16x32_bf16 v[48:51], a[104:107], v[96:99], 0
    ds_write_b128 v13, v[60:63] offset:58496
    v_mfma_f32_16x16x32_bf16 v[52:55], a[104:107], v[100:103], 0
    ds_write_b128 v15, v[64:67] offset:49280
    v_mfma_f32_16x16x32_bf16 v[56:59], a[104:107], v[104:107], 0
    ds_write_b128 v15, v[68:71] offset:50304
    v_mfma_f32_16x16x32_bf16 v[60:63], a[104:107], v[108:111], 0
    ds_write_b128 v15, v[72:75] offset:57472
    v_mfma_f32_16x16x32_bf16 v[64:67], a[108:111], v[96:99], 0
    ds_write_b128 v15, v[76:79] offset:58496
    v_mfma_f32_16x16x32_bf16 v[68:71], a[108:111], v[100:103], 0
    v_mfma_f32_16x16x32_bf16 v[72:75], a[108:111], v[104:107], 0
    v_mfma_f32_16x16x32_bf16 v[76:79], a[108:111], v[108:111], 0
    s_add_u32 s93, s93, 4096
    s_branch L_join_29
L_nrm_28:
    v_mfma_f32_16x16x32_bf16 v[16:19], a[96:99], v[96:99], v[16:19]
    v_mfma_f32_16x16x32_bf16 v[20:23], a[96:99], v[100:103], v[20:23]
    buffer_load_dwordx4 v[80:83], v8, s[56:59], s93 offen sc1
    v_mfma_f32_16x16x32_bf16 v[24:27], a[96:99], v[104:107], v[24:27]
    v_mfma_f32_16x16x32_bf16 v[28:31], a[96:99], v[108:111], v[28:31]
    buffer_load_dwordx4 v[84:87], v8, s[56:59], s93 offen offset:1024 sc1
    v_mfma_f32_16x16x32_bf16 v[32:35], a[100:103], v[96:99], v[32:35]
    v_mfma_f32_16x16x32_bf16 v[36:39], a[100:103], v[100:103], v[36:39]
    buffer_load_dwordx4 v[88:91], v8, s[56:59], s93 offen offset:2048 sc1
    v_mfma_f32_16x16x32_bf16 v[40:43], a[100:103], v[104:107], v[40:43]
    v_mfma_f32_16x16x32_bf16 v[44:47], a[100:103], v[108:111], v[44:47]
    buffer_load_dwordx4 v[92:95], v8, s[56:59], s93 offen offset:3072 sc1
    v_mfma_f32_16x16x32_bf16 v[48:51], a[104:107], v[96:99], v[48:51]
    v_mfma_f32_16x16x32_bf16 v[52:55], a[104:107], v[100:103], v[52:55]
    v_mfma_f32_16x16x32_bf16 v[56:59], a[104:107], v[104:107], v[56:59]
    v_mfma_f32_16x16x32_bf16 v[60:63], a[104:107], v[108:111], v[60:63]
    v_mfma_f32_16x16x32_bf16 v[64:67], a[108:111], v[96:99], v[64:67]
    v_mfma_f32_16x16x32_bf16 v[68:71], a[108:111], v[100:103], v[68:71]
    v_mfma_f32_16x16x32_bf16 v[72:75], a[108:111], v[104:107], v[72:75]
    v_mfma_f32_16x16x32_bf16 v[76:79], a[108:111], v[108:111], v[76:79]
    s_add_u32 s93, s93, 4096
L_join_29:
    s_waitcnt vmcnt(4)
    v_mfma_f32_16x16x32_bf16 v[16:19], a[112:115], v[112:115], v[16:19]
    v_mfma_f32_16x16x32_bf16 v[20:23], a[112:115], v[116:119], v[20:23]
    buffer_load_dwordx4 v[96:99], v8, s[56:59], s93 offen sc1
    v_mfma_f32_16x16x32_bf16 v[24:27], a[112:115], v[120:123], v[24:27]
    v_mfma_f32_16x16x32_bf16 v[28:31], a[112:115], v[124:127], v[28:31]
    buffer_load_dwordx4 v[100:103], v8, s[56:59], s93 offen offset:1024 sc1
    v_mfma_f32_16x16x32_bf16 v[32:35], a[116:119], v[112:115], v[32:35]
    v_mfma_f32_16x16x32_bf16 v[36:39], a[116:119], v[116:119], v[36:39]
    buffer_load_dwordx4 v[104:107], v8, s[56:59], s93 offen offset:2048 sc1
    v_mfma_f32_16x16x32_bf16 v[40:43], a[116:119], v[120:123], v[40:43]
    v_mfma_f32_16x16x32_bf16 v[44:47], a[116:119], v[124:127], v[44:47]
    buffer_load_dwordx4 v[108:111], v8, s[56:59], s93 offen offset:3072 sc1
    v_mfma_f32_16x16x32_bf16 v[48:51], a[120:123], v[112:115], v[48:51]
    v_mfma_f32_16x16x32_bf16 v[52:55], a[120:123], v[116:119], v[52:55]
    v_mfma_f32_16x16x32_bf16 v[56:59], a[120:123], v[120:123], v[56:59]
    v_mfma_f32_16x16x32_bf16 v[60:63], a[120:123], v[124:127], v[60:63]
    v_mfma_f32_16x16x32_bf16 v[64:67], a[124:127], v[112:115], v[64:67]
    v_mfma_f32_16x16x32_bf16 v[68:71], a[124:127], v[116:119], v[68:71]
    v_mfma_f32_16x16x32_bf16 v[72:75], a[124:127], v[120:123], v[72:75]
    v_mfma_f32_16x16x32_bf16 v[76:79], a[124:127], v[124:127], v[76:79]
    s_add_u32 s93, s93, 4096
    s_waitcnt vmcnt(4)
    v_mfma_f32_16x16x32_bf16 v[16:19], a[128:131], v[80:83], v[16:19]
    v_mfma_f32_16x16x32_bf16 v[20:23], a[128:131], v[84:87], v[20:23]
    buffer_load_dwordx4 v[112:115], v8, s[56:59], s93 offen sc1
    v_mfma_f32_16x16x32_bf16 v[24:27], a[128:131], v[88:91], v[24:27]
    v_mfma_f32_16x16x32_bf16 v[28:31], a[128:131], v[92:95], v[28:31]
    buffer_load_dwordx4 v[116:119], v8, s[56:59], s93 offen offset:1024 sc1
    v_mfma_f32_16x16x32_bf16 v[32:35], a[132:135], v[80:83], v[32:35]
    v_mfma_f32_16x16x32_bf16 v[36:39], a[132:135], v[84:87], v[36:39]
    buffer_load_dwordx4 v[120:123], v8, s[56:59], s93 offen offset:2048 sc1
    v_mfma_f32_16x16x32_bf16 v[40:43], a[132:135], v[88:91], v[40:43]
    v_mfma_f32_16x16x32_bf16 v[44:47], a[132:135], v[92:95], v[44:47]
    buffer_load_dwordx4 v[124:127], v8, s[56:59], s93 offen offset:3072 sc1
    v_mfma_f32_16x16x32_bf16 v[48:51], a[136:139], v[80:83], v[48:51]
    v_mfma_f32_16x16x32_bf16 v[52:55], a[136:139], v[84:87], v[52:55]
    v_mfma_f32_16x16x32_bf16 v[56:59], a[136:139], v[88:91], v[56:59]
    v_mfma_f32_16x16x32_bf16 v[60:63], a[136:139], v[92:95], v[60:63]
    v_mfma_f32_16x16x32_bf16 v[64:67], a[140:143], v[80:83], v[64:67]
    v_mfma_f32_16x16x32_bf16 v[68:71], a[140:143], v[84:87], v[68:71]
    v_mfma_f32_16x16x32_bf16 v[72:75], a[140:143], v[88:91], v[72:75]
    v_mfma_f32_16x16x32_bf16 v[76:79], a[140:143], v[92:95], v[76:79]
    s_add_u32 s93, s93, 4096
    s_waitcnt vmcnt(4)
    v_mfma_f32_16x16x32_bf16 v[16:19], a[144:147], v[96:99], v[16:19]
    v_mfma_f32_16x16x32_bf16 v[20:23], a[144:147], v[100:103], v[20:23]
    buffer_load_dwordx4 v[80:83], v8, s[56:59], s93 offen sc1
    v_mfma_f32_16x16x32_bf16 v[24:27], a[144:147], v[104:107], v[24:27]
    v_mfma_f32_16x16x32_bf16 v[28:31], a[144:147], v[108:111], v[28:31]
    buffer_load_dwordx4 v[84:87], v8, s[56:59], s93 offen offset:1024 sc1
    v_mfma_f32_16x16x32_bf16 v[32:35], a[148:151], v[96:99], v[32:35]
    v_mfma_f32_16x16x32_bf16 v[36:39], a[148:151], v[100:103], v[36:39]
    buffer_load_dwordx4 v[88:91], v8, s[56:59], s93 offen offset:2048 sc1
    v_mfma_f32_16x16x32_bf16 v[40:43], a[148:151], v[104:107], v[40:43]
    v_mfma_f32_16x16x32_bf16 v[44:47], a[148:151], v[108:111], v[44:47]
    buffer_load_dwordx4 v[92:95], v8, s[56:59], s93 offen offset:3072 sc1
    v_mfma_f32_16x16x32_bf16 v[48:51], a[152:155], v[96:99], v[48:51]
    v_mfma_f32_16x16x32_bf16 v[52:55], a[152:155], v[100:103], v[52:55]
    v_mfma_f32_16x16x32_bf16 v[56:59], a[152:155], v[104:107], v[56:59]
    v_mfma_f32_16x16x32_bf16 v[60:63], a[152:155], v[108:111], v[60:63]
    v_mfma_f32_16x16x32_bf16 v[64:67], a[156:159], v[96:99], v[64:67]
    v_mfma_f32_16x16x32_bf16 v[68:71], a[156:159], v[100:103], v[68:71]
    v_mfma_f32_16x16x32_bf16 v[72:75], a[156:159], v[104:107], v[72:75]
    v_mfma_f32_16x16x32_bf16 v[76:79], a[156:159], v[108:111], v[76:79]
    s_add_u32 s93, s93, 4096
    s_waitcnt vmcnt(4)
    v_mfma_f32_16x16x32_bf16 v[16:19], a[160:163], v[112:115], v[16:19]
    v_mfma_f32_16x16x32_bf16 v[20:23], a[160:163], v[116:119], v[20:23]
    buffer_load_dwordx4 v[96:99], v8, s[56:59], s93 offen sc1
    v_mfma_f32_16x16x32_bf16 v[24:27], a[160:163], v[120:123], v[24:27]
    v_mfma_f32_16x16x32_bf16 v[28:31], a[160:163], v[124:127], v[28:31]
    buffer_load_dwordx4 v[100:103], v8, s[56:59], s93 offen offset:1024 sc1
    v_mfma_f32_16x16x32_bf16 v[32:35], a[164:167], v[112:115], v[32:35]
    v_mfma_f32_16x16x32_bf16 v[36:39], a[164:167], v[116:119], v[36:39]
    buffer_load_dwordx4 v[104:107], v8, s[56:59], s93 offen offset:2048 sc1
    v_mfma_f32_16x16x32_bf16 v[40:43], a[164:167], v[120:123], v[40:43]
    v_mfma_f32_16x16x32_bf16 v[44:47], a[164:167], v[124:127], v[44:47]
    buffer_load_dwordx4 v[108:111], v8, s[56:59], s93 offen offset:3072 sc1
    v_mfma_f32_16x16x32_bf16 v[48:51], a[168:171], v[112:115], v[48:51]
    v_mfma_f32_16x16x32_bf16 v[52:55], a[168:171], v[116:119], v[52:55]
    v_mfma_f32_16x16x32_bf16 v[56:59], a[168:171], v[120:123], v[56:59]
    v_mfma_f32_16x16x32_bf16 v[60:63], a[168:171], v[124:127], v[60:63]
    v_mfma_f32_16x16x32_bf16 v[64:67], a[172:175], v[112:115], v[64:67]
    v_mfma_f32_16x16x32_bf16 v[68:71], a[172:175], v[116:119], v[68:71]
    v_mfma_f32_16x16x32_bf16 v[72:75], a[172:175], v[120:123], v[72:75]
    v_mfma_f32_16x16x32_bf16 v[76:79], a[172:175], v[124:127], v[76:79]
    s_add_u32 s93, s93, 4096
    s_waitcnt vmcnt(4)
    v_mfma_f32_16x16x32_bf16 v[16:19], a[176:179], v[80:83], v[16:19]
    v_mfma_f32_16x16x32_bf16 v[20:23], a[176:179], v[84:87], v[20:23]
    buffer_load_dwordx4 v[112:115], v8, s[56:59], s93 offen sc1
    v_mfma_f32_16x16x32_bf16 v[24:27], a[176:179], v[88:91], v[24:27]
    v_mfma_f32_16x16x32_bf16 v[28:31], a[176:179], v[92:95], v[28:31]
    buffer_load_dwordx4 v[116:119], v8, s[56:59], s93 offen offset:1024 sc1
    v_mfma_f32_16x16x32_bf16 v[32:35], a[180:183], v[80:83], v[32:35]
    v_mfma_f32_16x16x32_bf16 v[36:39], a[180:183], v[84:87], v[36:39]
    buffer_load_dwordx4 v[120:123], v8, s[56:59], s93 offen offset:2048 sc1
    v_mfma_f32_16x16x32_bf16 v[40:43], a[180:183], v[88:91], v[40:43]
    v_mfma_f32_16x16x32_bf16 v[44:47], a[180:183], v[92:95], v[44:47]
    buffer_load_dwordx4 v[124:127], v8, s[56:59], s93 offen offset:3072 sc1
    v_mfma_f32_16x16x32_bf16 v[48:51], a[184:187], v[80:83], v[48:51]
    v_mfma_f32_16x16x32_bf16 v[52:55], a[184:187], v[84:87], v[52:55]
    v_mfma_f32_16x16x32_bf16 v[56:59], a[184:187], v[88:91], v[56:59]
    v_mfma_f32_16x16x32_bf16 v[60:63], a[184:187], v[92:95], v[60:63]
    v_mfma_f32_16x16x32_bf16 v[64:67], a[188:191], v[80:83], v[64:67]
    v_mfma_f32_16x16x32_bf16 v[68:71], a[188:191], v[84:87], v[68:71]
    v_mfma_f32_16x16x32_bf16 v[72:75], a[188:191], v[88:91], v[72:75]
    v_mfma_f32_16x16x32_bf16 v[76:79], a[188:191], v[92:95], v[76:79]
    s_add_u32 s93, s93, 4096
    s_waitcnt vmcnt(4)
    v_mfma_f32_16x16x32_bf16 v[16:19], v[128:131], v[96:99], v[16:19]
    v_mfma_f32_16x16x32_bf16 v[20:23], v[128:131], v[100:103], v[20:23]
    buffer_load_dwordx4 v[80:83], v8, s[56:59], s93 offen sc1
    v_mfma_f32_16x16x32_bf16 v[24:27], v[128:131], v[104:107], v[24:27]
    v_mfma_f32_16x16x32_bf16 v[28:31], v[128:131], v[108:111], v[28:31]
    buffer_load_dwordx4 v[84:87], v8, s[56:59], s93 offen offset:1024 sc1
    v_mfma_f32_16x16x32_bf16 v[32:35], v[132:135], v[96:99], v[32:35]
    s_lshl_b32 s3, s92, 6
    s_lshl_b32 s7, s6, 4
    s_add_u32 s3, s3, s7
    v_add_u32 v14, s3, v3
    s_lshl_b32 s7, s89, 7
    v_lshl_add_u32 v10, v2, 3, s7
    v_lshlrev_b32_e64 v9, 10, v14
    v_add_u32_e64 v9, v9, v10
    v_lshlrev_b32 v11, 3, v14
    v_add_u32 v11, 11665408, v11
    s_mov_b32 s84, 0
    buffer_load_dwordx2 v[224:225], v9, s[8:11], s84 offen
    v_mfma_f32_16x16x32_bf16 v[36:39], v[132:135], v[100:103], v[36:39]
    buffer_load_dwordx4 v[88:91], v8, s[56:59], s93 offen offset:2048 sc1
    v_mfma_f32_16x16x32_bf16 v[40:43], v[132:135], v[104:107], v[40:43]
    v_mfma_f32_16x16x32_bf16 v[44:47], v[132:135], v[108:111], v[44:47]
    buffer_load_dwordx4 v[92:95], v8, s[56:59], s93 offen offset:3072 sc1
    v_mfma_f32_16x16x32_bf16 v[48:51], v[136:139], v[96:99], v[48:51]
    v_mfma_f32_16x16x32_bf16 v[52:55], v[136:139], v[100:103], v[52:55]
    v_mfma_f32_16x16x32_bf16 v[56:59], v[136:139], v[104:107], v[56:59]
    s_add_u32 s84, s84, 4096
    buffer_load_dwordx2 v[226:227], v9, s[8:11], s84 offen
    s_add_u32 s84, s84, 4096
    buffer_load_dwordx2 v[228:229], v9, s[8:11], s84 offen
    s_add_u32 s84, s84, 4096
    buffer_load_dwordx2 v[230:231], v9, s[8:11], s84 offen
    buffer_load_dwordx2 v[240:241], v11, s[56:59], 0 offen offset:0 sc1
    v_mfma_f32_16x16x32_bf16 v[60:63], v[136:139], v[108:111], v[60:63]
    v_mfma_f32_16x16x32_bf16 v[64:67], v[140:143], v[96:99], v[64:67]
    v_mfma_f32_16x16x32_bf16 v[68:71], v[140:143], v[100:103], v[68:71]
    v_mfma_f32_16x16x32_bf16 v[72:75], v[140:143], v[104:107], v[72:75]
    v_mfma_f32_16x16x32_bf16 v[76:79], v[140:143], v[108:111], v[76:79]
    s_add_u32 s93, s93, 4096
    s_waitcnt vmcnt(9)
    v_mfma_f32_16x16x32_bf16 v[16:19], v[144:147], v[112:115], v[16:19]
    v_mfma_f32_16x16x32_bf16 v[20:23], v[144:147], v[116:119], v[20:23]
    buffer_load_dwordx4 v[96:99], v8, s[56:59], s93 offen sc1
    v_mfma_f32_16x16x32_bf16 v[24:27], v[144:147], v[120:123], v[24:27]
    v_mfma_f32_16x16x32_bf16 v[28:31], v[144:147], v[124:127], v[28:31]
    buffer_load_dwordx4 v[100:103], v8, s[56:59], s93 offen offset:1024 sc1
    v_mfma_f32_16x16x32_bf16 v[32:35], v[148:151], v[112:115], v[32:35]
    buffer_load_dwordx2 v[242:243], v11, s[56:59], 0 offen offset:32 sc1
    v_mfma_f32_16x16x32_bf16 v[36:39], v[148:151], v[116:119], v[36:39]
    buffer_load_dwordx4 v[104:107], v8, s[56:59], s93 offen offset:2048 sc1
    v_mfma_f32_16x16x32_bf16 v[40:43], v[148:151], v[120:123], v[40:43]
    v_mfma_f32_16x16x32_bf16 v[44:47], v[148:151], v[124:127], v[44:47]
    buffer_load_dwordx4 v[108:111], v8, s[56:59], s93 offen offset:3072 sc1
    v_mfma_f32_16x16x32_bf16 v[48:51], v[152:155], v[112:115], v[48:51]
    v_mfma_f32_16x16x32_bf16 v[52:55], v[152:155], v[116:119], v[52:55]
    v_mfma_f32_16x16x32_bf16 v[56:59], v[152:155], v[120:123], v[56:59]
    buffer_load_dwordx2 v[244:245], v11, s[56:59], 0 offen offset:64 sc1
    v_mfma_f32_16x16x32_bf16 v[60:63], v[152:155], v[124:127], v[60:63]
    v_mfma_f32_16x16x32_bf16 v[64:67], v[156:159], v[112:115], v[64:67]
    v_mfma_f32_16x16x32_bf16 v[68:71], v[156:159], v[116:119], v[68:71]
    v_mfma_f32_16x16x32_bf16 v[72:75], v[156:159], v[120:123], v[72:75]
    v_mfma_f32_16x16x32_bf16 v[76:79], v[156:159], v[124:127], v[76:79]
    s_add_u32 s93, s93, 4096
    s_waitcnt vmcnt(10)
    v_mfma_f32_16x16x32_bf16 v[16:19], v[160:163], v[80:83], v[16:19]
    v_mfma_f32_16x16x32_bf16 v[20:23], v[160:163], v[84:87], v[20:23]
    buffer_load_dwordx4 v[112:115], v8, s[56:59], s93 offen sc1
    v_mfma_f32_16x16x32_bf16 v[24:27], v[160:163], v[88:91], v[24:27]
    v_mfma_f32_16x16x32_bf16 v[28:31], v[160:163], v[92:95], v[28:31]
    buffer_load_dwordx4 v[116:119], v8, s[56:59], s93 offen offset:1024 sc1
    v_mfma_f32_16x16x32_bf16 v[32:35], v[164:167], v[80:83], v[32:35]
    buffer_load_dwordx2 v[246:247], v11, s[56:59], 0 offen offset:96 sc1
    v_mfma_f32_16x16x32_bf16 v[36:39], v[164:167], v[84:87], v[36:39]
    buffer_load_dwordx4 v[120:123], v8, s[56:59], s93 offen offset:2048 sc1
    v_mfma_f32_16x16x32_bf16 v[40:43], v[164:167], v[88:91], v[40:43]
    v_mfma_f32_16x16x32_bf16 v[44:47], v[164:167], v[92:95], v[44:47]
    buffer_load_dwordx4 v[124:127], v8, s[56:59], s93 offen offset:3072 sc1
    v_mfma_f32_16x16x32_bf16 v[48:51], v[168:171], v[80:83], v[48:51]
    v_mfma_f32_16x16x32_bf16 v[52:55], v[168:171], v[84:87], v[52:55]
    v_mfma_f32_16x16x32_bf16 v[56:59], v[168:171], v[88:91], v[56:59]
    global_load_dwordx2 v[252:253], v10, s[32:33]
    v_mfma_f32_16x16x32_bf16 v[60:63], v[168:171], v[92:95], v[60:63]
    v_mfma_f32_16x16x32_bf16 v[64:67], v[172:175], v[80:83], v[64:67]
    v_mfma_f32_16x16x32_bf16 v[68:71], v[172:175], v[84:87], v[68:71]
    v_mfma_f32_16x16x32_bf16 v[72:75], v[172:175], v[88:91], v[72:75]
    v_mfma_f32_16x16x32_bf16 v[76:79], v[172:175], v[92:95], v[76:79]
    s_add_u32 s93, s93, 4096
    s_waitcnt vmcnt(7)
    v_mfma_f32_16x16x32_bf16 v[16:19], v[176:179], v[96:99], v[16:19]
    v_mfma_f32_16x16x32_bf16 v[20:23], v[176:179], v[100:103], v[20:23]
    buffer_load_dwordx4 v[80:83], v8, s[56:59], s93 offen sc1
    v_mfma_f32_16x16x32_bf16 v[24:27], v[176:179], v[104:107], v[24:27]
    v_mfma_f32_16x16x32_bf16 v[28:31], v[176:179], v[108:111], v[28:31]
    buffer_load_dwordx4 v[84:87], v8, s[56:59], s93 offen offset:1024 sc1
    v_mfma_f32_16x16x32_bf16 v[32:35], v[180:183], v[96:99], v[32:35]
    global_load_dwordx2 v[250:251], v10, s[42:43]
    s_mov_b32 s12, s46
    s_and_b32 s13, s47, 0xffff
    s_mov_b32 s14, 0x400000
    v_mfma_f32_16x16x32_bf16 v[36:39], v[180:183], v[100:103], v[36:39]
    buffer_load_dwordx4 v[88:91], v8, s[56:59], s93 offen offset:2048 sc1
    v_mfma_f32_16x16x32_bf16 v[40:43], v[180:183], v[104:107], v[40:43]
    v_mfma_f32_16x16x32_bf16 v[44:47], v[180:183], v[108:111], v[44:47]
    buffer_load_dwordx4 v[92:95], v8, s[56:59], s93 offen offset:3072 sc1
    v_mfma_f32_16x16x32_bf16 v[48:51], v[184:187], v[96:99], v[48:51]
    v_mfma_f32_16x16x32_bf16 v[52:55], v[184:187], v[100:103], v[52:55]
    v_mfma_f32_16x16x32_bf16 v[56:59], v[184:187], v[104:107], v[56:59]
    s_mov_b32 s15, 0x20000
    v_mfma_f32_16x16x32_bf16 v[60:63], v[184:187], v[108:111], v[60:63]
    v_mfma_f32_16x16x32_bf16 v[64:67], v[188:191], v[96:99], v[64:67]
    v_mfma_f32_16x16x32_bf16 v[68:71], v[188:191], v[100:103], v[68:71]
    v_mfma_f32_16x16x32_bf16 v[72:75], v[188:191], v[104:107], v[72:75]
    v_mfma_f32_16x16x32_bf16 v[76:79], v[188:191], v[108:111], v[76:79]
    s_add_u32 s93, s93, 4096
    s_waitcnt vmcnt(6)
    v_mfma_f32_16x16x32_bf16 v[16:19], v[192:195], v[112:115], v[16:19]
    s_lshl_b32 s3, s6, 4
    v_add_u32 v6, s3, v3
    v_lshlrev_b32 v6, 8, v6
    v_mfma_f32_16x16x32_bf16 v[20:23], v[192:195], v[116:119], v[20:23]
    v_add_u32 v6, 65536, v6
    v_xor_b32 v7, v2, v3
    v_mfma_f32_16x16x32_bf16 v[24:27], v[192:195], v[120:123], v[24:27]
    v_xor_b32 v5, 4, v7
    v_lshl_add_u32 v5, v5, 4, v6
    v_mfma_f32_16x16x32_bf16 v[28:31], v[192:195], v[124:127], v[28:31]
    v_lshl_add_u32 v6, v7, 4, v6
    v_mov_b32_e64 v7, v5
    v_mfma_f32_16x16x32_bf16 v[32:35], v[196:199], v[112:115], v[32:35]
    v_add_u32 v4, 65536, v6
    v_add_u32 v5, 65536, v7
    v_mfma_f32_16x16x32_bf16 v[36:39], v[196:199], v[116:119], v[36:39]
    v_lshlrev_b32 v9, 11, v14
    s_lshl_b32 s3, s89, 8
    v_lshl_add_u32 v10, v2, 4, s3
    v_mfma_f32_16x16x32_bf16 v[40:43], v[196:199], v[120:123], v[40:43]
    v_add_u32 v9, v9, v10
    s_waitcnt vmcnt(2)
    v_mfma_f32_16x16x32_bf16 v[44:47], v[196:199], v[124:127], v[44:47]
    v_lshlrev_b32 v128, 16, v252
    v_and_b32 v129, 0xffff0000, v252
    v_mfma_f32_16x16x32_bf16 v[48:51], v[200:203], v[112:115], v[48:51]
    v_lshlrev_b32 v130, 16, v253
    v_and_b32 v131, 0xffff0000, v253
    v_mfma_f32_16x16x32_bf16 v[52:55], v[200:203], v[116:119], v[52:55]
    v_lshlrev_b32_e64 v132, 16, v250
    v_and_b32 v133, 0xffff0000, v250
    v_mfma_f32_16x16x32_bf16 v[56:59], v[200:203], v[120:123], v[56:59]
    v_lshlrev_b32 v134, 16, v251
    v_and_b32 v135, 0xffff0000, v251
    v_mfma_f32_16x16x32_bf16 v[60:63], v[200:203], v[124:127], v[60:63]
    v_lshlrev_b32 v136, 16, v224
    v_and_b32 v137, 0xffff0000, v224
    v_mfma_f32_16x16x32_bf16 v[64:67], v[204:207], v[112:115], v[64:67]
    v_lshlrev_b32_e64 v138, 16, v225
    v_and_b32 v139, 0xffff0000, v225
    v_mfma_f32_16x16x32_bf16 v[68:71], v[204:207], v[116:119], v[68:71]
    v_pk_mul_f32 v[136:137], v[136:137], v[128:129]
    v_pk_mul_f32 v[138:139], v[138:139], v[130:131]
    v_mfma_f32_16x16x32_bf16 v[72:75], v[204:207], v[120:123], v[72:75]
    v_cvt_pk_bf16_f32 v140, v136, v137
    v_cvt_pk_bf16_f32 v141, v138, v139
    v_mfma_f32_16x16x32_bf16 v[76:79], v[204:207], v[124:127], v[76:79]
    v_lshlrev_b32_e64 v136, 16, v140
    v_and_b32 v137, 0xffff0000, v140
    s_waitcnt vmcnt(0)
    v_mfma_f32_16x16x32_bf16 v[16:19], v[208:211], v[80:83], v[16:19]
    v_lshlrev_b32 v138, 16, v141
    v_mfma_f32_16x16x32_bf16 v[20:23], v[208:211], v[84:87], v[20:23]
    v_and_b32 v139, 0xffff0000, v141
    v_mfma_f32_16x16x32_bf16 v[24:27], v[208:211], v[88:91], v[24:27]
    v_lshlrev_b32_e64 v144, 16, v226
    v_mfma_f32_16x16x32_bf16 v[28:31], v[208:211], v[92:95], v[28:31]
    v_and_b32 v145, 0xffff0000, v226
    v_mfma_f32_16x16x32_bf16 v[32:35], v[212:215], v[80:83], v[32:35]
    v_lshlrev_b32_e64 v146, 16, v227
    v_mfma_f32_16x16x32_bf16 v[36:39], v[212:215], v[84:87], v[36:39]
    v_and_b32 v147, 0xffff0000, v227
    v_mfma_f32_16x16x32_bf16 v[40:43], v[212:215], v[88:91], v[40:43]
    v_pk_mul_f32 v[144:145], v[144:145], v[128:129]
    v_mfma_f32_16x16x32_bf16 v[44:47], v[212:215], v[92:95], v[44:47]
    v_pk_mul_f32 v[146:147], v[146:147], v[130:131]
    v_mfma_f32_16x16x32_bf16 v[48:51], v[216:219], v[80:83], v[48:51]
    ds_write_b128 v13, v[16:19] offset:0
    v_cvt_pk_bf16_f32 v148, v144, v145
    v_mfma_f32_16x16x32_bf16 v[52:55], v[216:219], v[84:87], v[52:55]
    ds_write_b128 v13, v[20:23] offset:1024
    v_cvt_pk_bf16_f32 v149, v146, v147
    v_mfma_f32_16x16x32_bf16 v[56:59], v[216:219], v[88:91], v[56:59]
    ds_write_b128 v13, v[24:27] offset:8192
    v_lshlrev_b32_e64 v144, 16, v148
    v_mfma_f32_16x16x32_bf16 v[60:63], v[216:219], v[92:95], v[60:63]
    ds_write_b128 v13, v[28:31] offset:9216
    v_and_b32 v145, 0xffff0000, v148
    v_mfma_f32_16x16x32_bf16 v[64:67], v[220:223], v[80:83], v[64:67]
    ds_write_b128 v15, v[32:35] offset:0
    v_lshlrev_b32_e64 v146, 16, v149
    v_mfma_f32_16x16x32_bf16 v[68:71], v[220:223], v[84:87], v[68:71]
    ds_write_b128 v15, v[36:39] offset:1024
    v_and_b32 v147, 0xffff0000, v149
    v_mfma_f32_16x16x32_bf16 v[72:75], v[220:223], v[88:91], v[72:75]
    ds_write_b128 v15, v[40:43] offset:8192
    v_lshlrev_b32_e64 v152, 16, v228
    v_mfma_f32_16x16x32_bf16 v[76:79], v[220:223], v[92:95], v[76:79]
    ds_write_b128 v15, v[44:47] offset:9216
    v_and_b32 v153, 0xffff0000, v228
    s_nop 1
    v_lshlrev_b32 v154, 16, v229
    v_and_b32 v155, 0xffff0000, v229
    v_pk_mul_f32 v[152:153], v[152:153], v[128:129]
    ds_write_b128 v13, v[48:51] offset:128
    v_pk_mul_f32 v[154:155], v[154:155], v[130:131]
    v_cvt_pk_bf16_f32 v156, v152, v153
    v_cvt_pk_bf16_f32 v157, v154, v155
    ds_write_b128 v13, v[52:55] offset:1152
    v_lshlrev_b32 v152, 16, v156
    v_and_b32 v153, 0xffff0000, v156
    v_lshlrev_b32 v154, 16, v157
    ds_write_b128 v13, v[56:59] offset:8320
    v_and_b32 v155, 0xffff0000, v157
    v_lshlrev_b32 v160, 16, v230
    v_and_b32 v161, 0xffff0000, v230
    ds_write_b128 v13, v[60:63] offset:9344
    v_lshlrev_b32 v162, 16, v231
    v_and_b32 v163, 0xffff0000, v231
    v_pk_mul_f32 v[160:161], v[160:161], v[128:129]
    ds_write_b128 v15, v[64:67] offset:128
    v_pk_mul_f32 v[162:163], v[162:163], v[130:131]
    v_cvt_pk_bf16_f32 v164, v160, v161
    v_cvt_pk_bf16_f32 v165, v162, v163
    ds_write_b128 v15, v[68:71] offset:1152
    v_lshlrev_b32_e64 v160, 16, v164
    v_and_b32 v161, 0xffff0000, v164
    v_lshlrev_b32_e64 v162, 16, v165
    ds_write_b128 v15, v[72:75] offset:8320
    v_and_b32 v163, 0xffff0000, v165
    ds_write_b128 v15, v[76:79] offset:9344
    s_waitcnt lgkmcnt(0)
    s_barrier
    ds_read_b128 v[16:19], v6 offset:0
    ds_read_b128 v[20:23], v6 offset:16384
    ds_read_b128 v[24:27], v6 offset:32768
    ds_read_b128 v[28:31], v6 offset:49152
    ds_read_b128 v[32:35], v4 offset:0
    ds_read_b128 v[36:39], v6 offset:1024
    ds_read_b128 v[40:43], v6 offset:17408
    ds_read_b128 v[44:47], v6 offset:33792
    ds_read_b128 v[48:51], v6 offset:50176
    ds_read_b128 v[52:55], v4 offset:1024
    ds_read_b128 v[56:59], v7 offset:2048
    ds_read_b128 v[60:63], v7 offset:18432
    ds_read_b128 v[64:67], v7 offset:34816
    ds_read_b128 v[68:71], v7 offset:51200
    ds_read_b128 v[72:75], v5 offset:2048
    ds_read_b128 v[76:79], v7 offset:3072
    ds_read_b128 v[80:83], v7 offset:19456
    ds_read_b128 v[84:87], v7 offset:35840
    ds_read_b128 v[88:91], v7 offset:52224
    ds_read_b128 v[92:95], v5 offset:3072
    s_mov_b32 s84, 0
    s_waitcnt lgkmcnt(15)
    v_pk_add_f32 v[136:137], v[136:137], v[16:17]
    v_pk_add_f32 v[20:21], v[20:21], v[132:133]
    v_pk_add_f32 v[136:137], v[136:137], v[32:33]
    v_pk_add_f32 v[24:25], v[24:25], v[28:29]
    v_pk_add_f32 v[138:139], v[138:139], v[18:19]
    v_pk_add_f32 v[22:23], v[22:23], v[134:135]
    v_pk_add_f32 v[138:139], v[138:139], v[34:35]
    v_pk_add_f32 v[26:27], v[26:27], v[30:31]
    v_pk_add_f32 v[20:21], v[20:21], v[24:25]
    v_pk_add_f32 v[22:23], v[22:23], v[26:27]
    v_mul_f32 v136, v240, v136
    v_mul_f32 v137, v240, v137
    v_mul_f32 v138, v240, v138
    v_mul_f32 v139, v240, v139
    v_fmac_f32 v136, v241, v20
    v_fmac_f32 v137, v241, v21
    v_fmac_f32 v138, v241, v22
    v_fmac_f32_e64 v139, v241, v23
    buffer_store_dwordx4 v[136:139], v9, s[12:15], s84 offen sc1
    s_waitcnt lgkmcnt(10)
    v_pk_add_f32 v[144:145], v[144:145], v[36:37]
    v_pk_add_f32 v[40:41], v[40:41], v[132:133]
    v_pk_add_f32 v[144:145], v[144:145], v[52:53]
    v_pk_add_f32 v[44:45], v[44:45], v[48:49]
    v_pk_add_f32 v[146:147], v[146:147], v[38:39]
    v_pk_add_f32 v[42:43], v[42:43], v[134:135]
    v_pk_add_f32 v[146:147], v[146:147], v[54:55]
    v_pk_add_f32 v[46:47], v[46:47], v[50:51]
    v_pk_add_f32 v[40:41], v[40:41], v[44:45]
    v_pk_add_f32 v[42:43], v[42:43], v[46:47]
    v_mul_f32 v144, v242, v144
    v_mul_f32 v145, v242, v145
    v_mul_f32 v146, v242, v146
    v_mul_f32 v147, v242, v147
    v_fmac_f32 v144, v243, v40
    v_fmac_f32 v145, v243, v41
    v_fmac_f32 v146, v243, v42
    v_fmac_f32_e64 v147, v243, v43
    s_add_u32 s84, s84, 8192
    buffer_store_dwordx4 v[144:147], v9, s[12:15], s84 offen sc1
    s_waitcnt lgkmcnt(5)
    v_pk_add_f32 v[152:153], v[152:153], v[56:57]
    v_pk_add_f32 v[60:61], v[60:61], v[132:133]
    v_pk_add_f32 v[152:153], v[152:153], v[72:73]
    v_pk_add_f32 v[64:65], v[64:65], v[68:69]
    v_pk_add_f32 v[154:155], v[154:155], v[58:59]
    v_pk_add_f32 v[62:63], v[62:63], v[134:135]
    v_pk_add_f32 v[154:155], v[154:155], v[74:75]
    v_pk_add_f32 v[66:67], v[66:67], v[70:71]
    v_pk_add_f32 v[60:61], v[60:61], v[64:65]
    v_pk_add_f32 v[62:63], v[62:63], v[66:67]
    v_mul_f32 v152, v244, v152
    v_mul_f32 v153, v244, v153
    v_mul_f32_e64 v154, v244, v154
    v_mul_f32_e64 v155, v244, v155
    v_fmac_f32_e64 v152, v245, v60
    v_fmac_f32_e64 v153, v245, v61
    v_fmac_f32_e64 v154, v245, v62
    v_fmac_f32 v155, v245, v63
    s_add_u32 s84, s84, 8192
    buffer_store_dwordx4 v[152:155], v9, s[12:15], s84 offen sc1
    s_waitcnt lgkmcnt(0)
    v_pk_add_f32 v[160:161], v[160:161], v[76:77]
    v_pk_add_f32 v[80:81], v[80:81], v[132:133]
    v_pk_add_f32 v[160:161], v[160:161], v[92:93]
    v_pk_add_f32 v[84:85], v[84:85], v[88:89]
    v_pk_add_f32 v[162:163], v[162:163], v[78:79]
    v_pk_add_f32 v[82:83], v[82:83], v[134:135]
    v_pk_add_f32 v[162:163], v[162:163], v[94:95]
    v_pk_add_f32 v[86:87], v[86:87], v[90:91]
    v_pk_add_f32 v[80:81], v[80:81], v[84:85]
    v_pk_add_f32 v[82:83], v[82:83], v[86:87]
    v_mul_f32 v160, v246, v160
    v_mul_f32 v161, v246, v161
    v_mul_f32 v162, v246, v162
    v_mul_f32 v163, v246, v163
    v_fmac_f32 v160, v247, v80
    v_fmac_f32 v161, v247, v81
    v_fmac_f32 v162, v247, v82
    v_fmac_f32 v163, v247, v83
    s_add_u32 s84, s84, 8192
    buffer_store_dwordx4 v[160:163], v9, s[12:15], s84 offen sc1
L_k1_end:
    s_endpgm
L_code_end:
.section .rodata,"a"
.p2align 6
.amdhsa_kernel gated_mix__ssm_conv_s5__dense_activation_squared_relu__prompt_kernel
  .amdhsa_next_free_vgpr 512
  .amdhsa_next_free_sgpr 102
  .amdhsa_accum_offset 256
  .amdhsa_group_segment_fixed_size 0
  .amdhsa_kernarg_size 144
  .amdhsa_user_sgpr_count 2
  .amdhsa_user_sgpr_kernarg_segment_ptr 1
  .amdhsa_system_sgpr_workgroup_id_x 1
  .amdhsa_float_denorm_mode_32 3
.end_amdhsa_kernel
```
